```python
import torch

def _softmax(x, axis=-1):
    return torch.softmax(x, dim=axis)
def _gelu(x):
    return torch.nn.functional.gelu(x, approximate="tanh")
def _silu(x):
    return torch.nn.functional.silu(x)
def _sigmoid(x):
    return torch.sigmoid(x)
def _layernorm(x, axis=-1, eps=1e-5):
    m = x.mean(dim=axis, keepdim=True)
    v = x.var(dim=axis, keepdim=True, unbiased=False)
    return (x - m) / torch.sqrt(v + eps)
def _scatter_add(tgt, idx, src, axis=0):
    return tgt.clone().index_add_(axis, idx, src)
def _segment_sum(src, seg, n):
    out = torch.zeros((n,) + src.shape[1:], dtype=src.dtype)
    return out.index_add_(0, seg, src)
def _pad(x, pw):
    flat = tuple(v for pair in reversed(pw) for v in pair)
    return torch.nn.functional.pad(x, flat)

kernel_name = 'gated_mix__mha_block__ssm_conv_h3__prompt'

def setup_inputs():

    _w = (lambda a: (lambda t: t.to(torch.bfloat16) if t.is_floating_point() else t)(torch.as_tensor(a)))
    def _A_setup():
        B, S, D, H = 1, 2048, 640, 32
        return {
            "x": _w((lambda *s: torch.randn(*s, dtype=torch.bfloat16) * 0.05)(B, S, D)),
            "wqkv": _w((lambda *s: torch.randn(*s, dtype=torch.bfloat16) * 0.8)(D, 3 * D)),
            "wo": _w((lambda *s: torch.randn(*s, dtype=torch.bfloat16) * 0.05)(D, D)),
        }
    _A_in = _A_setup()

    def _B_setup():
        B, S, D = 1, 2048, 640
        ks = 4
        return {
            "q": _w((lambda *s: torch.randn(*s, dtype=torch.bfloat16) * 0.05)(B, S, D)),
            "k": _w((lambda *s: torch.randn(*s, dtype=torch.bfloat16) * 0.8)(B, S, D)),
            "v": _w((lambda *s: torch.randn(*s, dtype=torch.bfloat16) * 0.4)(B, S, D)),
            "shift_k": _w((lambda *s: torch.randn(*s, dtype=torch.bfloat16) * 0.8)(D, ks) * 0.5),
            "ssm_k": _w((lambda *s: torch.randn(*s, dtype=torch.bfloat16) * 0.8)(D, S) * (1.0 / S ** 0.5)),
            "ssm_D": _w((lambda *s: torch.randn(*s, dtype=torch.bfloat16) * 0.4)(D)),
        }
    _B_in = _B_setup()

    return {
        "A_x": _A_in["x"],
        "A_wqkv": _A_in["wqkv"],
        "A_wo": _A_in["wo"],
        "B_q": _B_in["q"],
        "B_k": _B_in["k"],
        "B_v": _B_in["v"],
        "B_shift_k": _B_in["shift_k"],
        "B_ssm_k": _B_in["ssm_k"],
        "B_ssm_D": _B_in["ssm_D"],
        "gate_w": _w((lambda *s: torch.randn(*s, dtype=torch.bfloat16) * 0.05)(640) * 16.0),
    }

def reference(A_x, A_wqkv, A_wo, B_q, B_k, B_v, B_shift_k, B_ssm_k, B_ssm_D, gate_w):
    def _A_ref(x, wqkv, wo):
        B, S, D = x.shape
        H = 32
        Dh = D // H
        qkv = (lambda x, *d: x.permute(*d))((x @ wqkv).reshape(B, S, 3, H, Dh), 2, 0, 3, 1, 4)
        q, k, v = qkv[0], qkv[1], qkv[2]
        scores = torch.einsum("bhqd,bhkd->bhqk", q, k) * (Dh ** -0.5)
        p = _softmax(scores, axis=-1)
        o = torch.einsum("bhqk,bhkd->bhqd", p, v)
        return (lambda x, *d: x.permute(*d))(o, 0, 2, 1, 3).reshape(B, S, D) @ wo

    def _B_ref(q, k, v, shift_k, ssm_k, ssm_D):
        B, S, D = q.shape
        ks = shift_k.shape[-1]
        k_pad = _pad(k, ((0, 0), (ks - 1, 0), (0, 0)))
        k_shift = torch.zeros_like(k)
        for t in range(ks):
            k_shift = k_shift + k_pad[:, t:t + S, :] * shift_k[:, ks - 1 - t][None, None, :]
        kv = k_shift * v
        L = 2 * S
        kv_pad = _pad(kv, ((0, 0), (0, S), (0, 0)))
        kf_pad = _pad(ssm_k, ((0, 0), (0, S)))
        kv_f = (lambda x, axes=(-2,-1): torch.fft.rfft2(x.float(), dim=axes))(kv_pad[:, None, :, :], axes=(1, 2))
        kf_f = (lambda x, axes=(-2,-1): torch.fft.rfft2(x.float(), dim=axes))(kf_pad[:, None, :], axes=(1, 2))
        kf_f = (lambda x, *d: x.permute(*d))(kf_f, 1, 2, 0)
        y_f = kv_f * kf_f[None, :, :, :]
        y = (lambda x, s, axes=(-2,-1): torch.fft.irfft2(x, s=s, dim=axes).to(torch.bfloat16))(y_f, (1, L), axes=(1, 2))[:, 0, :S, :]
        y = y + kv * ssm_D[None, None, :]
        return q * y

    x = A_x
    g = _sigmoid((x * gate_w).sum(-1, keepdims=True))
    a = _A_ref(x, A_wqkv, A_wo)
    b = _B_ref(x, B_k, B_v, B_shift_k, B_ssm_k, B_ssm_D)
    return g * a + (1 - g) * b
```

```asm
; @launch grid=(256,1,1) block=(512,1,1) lds=163840
.amdgcn_target "amdgcn-amd-amdhsa--gfx950"
.text
.globl gated_mix__mha_block__ssm_conv_h3__prompt_kernel
.p2align 8
.type gated_mix__mha_block__ssm_conv_h3__prompt_kernel,@function
gated_mix__mha_block__ssm_conv_h3__prompt_kernel:
    s_cmp_ge_u32 s2, 256
    s_cbranch_scc1 F_EXIT
    s_load_dwordx16 s[4:19], s[0:1], 0
    s_load_dwordx8 s[20:27], s[0:1], 64
    s_load_dwordx2 s[28:29], s[0:1], 96
    v_lshrrev_b32 v1, 6, v0
    v_and_b32 v255, 63, v0
    v_readfirstlane_b32 s3, v1
    s_and_b32 s30, s2, 7
    s_lshr_b32 s31, s2, 3
    s_cmp_eq_u32 s3, 1
    s_cbranch_scc0 F_NOIPF
    s_getpc_b64 s[32:33]
F_PC:
    s_mov_b32 s34, F_LAST-F_PC
    s_mov_b32 s35, 0x00020000
    v_lshlrev_b32 v1, 12, v255
    s_lshl_b32 s36, s31, 7
    buffer_load_dword v17, v1, s[32:35], s36 offen
F_NOIPF:
    s_lshr_b32 s48, s30, 1
    s_lshl_b32 s48, s48, 2
    s_and_b32 s51, s31, 3
    s_add_u32 s48, s48, s51
    s_and_b32 s49, s30, 1
    s_lshl_b32 s49, s49, 3
    s_lshr_b32 s51, s31, 2
    s_add_u32 s49, s49, s51
    s_lshl_b32 s51, s30, 2
    s_lshr_b32 s52, s31, 3
    s_add_u32 s51, s51, s52
    s_mul_i32 s51, s51, 81920
    s_and_b32 s52, s31, 7
    s_mul_i32 s52, s52, 160
    s_add_u32 s51, s51, s52
    s_mul_i32 s52, s3, 10240
    s_add_u32 s51, s51, s52
    v_mul_u32_u24 v2, 104858, v255
    v_lshrrev_b32 v2, 20, v2
    v_mul_u32_u24 v3, 10, v2
    v_sub_u32 v3, v255, v3
    v_mul_u32_u24 v2, 1280, v2
    v_lshl_add_u32 v2, v3, 4, v2
    v_add_u32 v12, s51, v2
    v_subrev_u32 v14, 3840, v12
    v_add_u32 v1, 64, v255
    v_mul_u32_u24 v2, 104858, v1
    v_lshrrev_b32 v2, 20, v2
    v_mul_u32_u24 v3, 10, v2
    v_sub_u32 v3, v1, v3
    v_mul_u32_u24 v2, 1280, v2
    v_lshl_add_u32 v2, v3, 4, v2
    v_add_u32 v13, s51, v2
    v_subrev_u32 v15, 3840, v13
    s_lshl_b32 s53, s3, 12
    s_add_u32 s53, s53, 98304
    s_cmp_ge_u32 s3, 4
    s_cbranch_scc1 F_H
    s_waitcnt lgkmcnt(0)
    s_lshl_b32 s92, s3, 8
    s_add_u32 s92, s92, s2
    s_cmp_lt_u32 s92, 8
    s_cbranch_scc0 F_NOZERO
    s_add_u32 s32, s28, 15794176
    s_addc_u32 s33, s29, 0
    s_mov_b32 s34, 24576
    s_mov_b32 s35, 0x00020000
    v_lshlrev_b32 v1, 4, v255
    v_mov_b32 v4, 0
    v_mov_b32 v5, 0
    v_mov_b32 v6, 0
    v_mov_b32 v7, 0
    s_mul_i32 s52, s92, 3072
    s_add_u32 s51, s52, 0
    buffer_store_dwordx4 v[4:7], v1, s[32:35], s51 offen offset:0 sc1
    buffer_store_dwordx4 v[4:7], v1, s[32:35], s51 offen offset:1024 sc1
    buffer_store_dwordx4 v[4:7], v1, s[32:35], s51 offen offset:2048 sc1
F_NOZERO:
    s_mov_b32 s40, s12
    s_mov_b32 s41, s13
    s_mov_b32 s42, 2621440
    s_mov_b32 s43, 0x00020000
    s_mov_b32 m0, s53
    s_mov_b32 s44, s14
    s_mov_b32 s45, s15
    s_mov_b32 s46, 2621440
    s_mov_b32 s47, 0x00020000
    buffer_load_dwordx4 v14, s[40:43], 0 offen nt lds
    s_add_u32 m0, s53, 1024
    s_mov_b32 exec_hi, 0x3fff
    buffer_load_dwordx4 v15, s[40:43], 0 offen nt lds
    s_add_u32 m0, s53, 2048
    s_mov_b64 exec, -1
    buffer_load_dwordx4 v12, s[44:47], 0 offen nt lds
    s_add_u32 m0, s53, 3072
    s_mov_b64 exec, 0xffff
    buffer_load_dwordx4 v13, s[44:47], 0 offen nt lds
    s_mov_b64 exec, -1
    s_mov_b32 s40, s16
    s_mov_b32 s41, s17
    s_mov_b32 s42, 5120
    s_mov_b32 s43, 0x00020000
    s_and_b32 s52, s31, 7
    s_mul_i32 s57, s52, 640
    v_lshlrev_b32 v1, 4, v255
    buffer_load_dwordx4 v[128:131], v1, s[40:43], s57 offen
    s_lshl_b32 s53, s3, 12
    s_add_u32 s53, s53, 98304
    s_mov_b32 s36, s26
    s_mov_b32 s37, s27
    s_mov_b32 s38, 256
    s_mov_b32 s39, 0x00020000
    s_cmp_lt_u32 s92, 8
    s_cbranch_scc0 F_NOINIT
    s_lshl_b32 s92, s92, 2
    v_mov_b32 v1, s92
    v_mov_b32 v2, 1
    s_waitcnt vmcnt(5)
    s_mov_b64 exec, 1
    buffer_store_dword v2, v1, s[36:39], 0 offen sc1
    s_mov_b64 exec, -1
F_NOINIT:
    s_lshl_b32 s51, s3, 8
    s_add_u32 s51, s51, s49
    s_cmp_eq_u32 s51, 15
    s_cbranch_scc0 F_NOG
    s_mov_b32 s32, s22
    s_mov_b32 s33, s23
    s_mov_b32 s34, 1280
    s_mov_b32 s35, 0x00020000
    v_lshlrev_b32 v1, 4, v255
    s_mov_b32 m0, 160000
    s_nop 0
    buffer_load_dwordx4 v1, s[32:35], 0 offen lds
    s_mov_b64 exec, 0xffff
    buffer_load_dwordx4 v1, s[32:35], 0 offen offset:1024 lds
    s_mov_b64 exec, -1
F_NOG:
    v_mov_b32 v1, 163776
    v_mov_b32 v4, 0
    v_mov_b32 v5, 0
    v_mov_b32 v6, 0
    v_mov_b32 v7, 0
    ds_write_b128 v1, v[4:7]
    ds_write_b128 v1, v[4:7] offset:16
    ds_write_b128 v1, v[4:7] offset:32
    v_and_b32 v1, 15, v255
    v_and_b32 v2, 1, v255
    v_lshl_add_u32 v2, v1, 1, v2
    s_and_b32 s51, s3, 1
    s_lshl_b32 s51, s51, 13
    v_lshl_add_u32 v2, v2, 7, s51
    v_lshrrev_b32 v3, 4, v255
    v_and_b32 v1, 7, v255
    v_xor_b32 v1, v1, v3
    v_xor_b32 v3, 0, v1
    v_lshl_add_u32 v100, v3, 4, v2
    v_xor_b32 v101, 128, v100
    v_xor_b32 v3, 4, v1
    v_lshl_add_u32 v102, v3, 4, v2
    v_xor_b32 v103, 128, v102
    v_add_u32 v104, 0x10000, v100
    v_add_u32 v105, 0x10000, v101
    v_add_u32 v106, 0x10000, v102
    v_add_u32 v107, 0x10000, v103
    v_bfe_u32 v1, v255, 2, 2
    v_lshrrev_b32 v2, 4, v255
    v_and_b32 v3, 1, v2
    v_lshl_add_u32 v2, v2, 3, v1
    v_lshlrev_b32 v2, 8, v2
    v_lshl_add_u32 v1, v1, 1, v3
    v_lshlrev_b32 v1, 1, v1
    v_and_b32 v3, 1, v255
    v_lshl_add_u32 v2, v3, 3, v2
    v_add_u32 v2, 16384, v2
    v_bfe_u32 v3, v255, 1, 1
    v_xor_b32 v1, v1, v3
    s_and_b32 s51, s3, 2
    s_lshl_b32 s51, s51, 2
    s_add_u32 s52, s51, 0
    v_xor_b32 v3, s52, v1
    v_lshl_add_u32 v108, v3, 4, v2
    v_add_u32 v116, 0x10000, v108
    s_add_u32 s52, s51, 2
    v_xor_b32 v3, s52, v1
    v_lshl_add_u32 v109, v3, 4, v2
    v_add_u32 v117, 0x10000, v109
    s_add_u32 s52, s51, 4
    v_xor_b32 v3, s52, v1
    v_lshl_add_u32 v110, v3, 4, v2
    v_add_u32 v118, 0x10000, v110
    s_add_u32 s52, s51, 6
    v_xor_b32 v3, s52, v1
    v_lshl_add_u32 v111, v3, 4, v2
    v_add_u32 v119, 0x10000, v111
    s_cmp_ge_u32 s49, 5
    s_cselect_b32 s51, 1, 0
    s_cmp_ge_u32 s49, 10
    s_cselect_b32 s51, 2, s51
    s_mul_i32 s52, s51, 5
    s_sub_u32 s52, s49, s52
    s_lshl_b32 s52, s52, 5
    s_and_b32 s57, s3, 2
    s_lshl_b32 s57, s57, 3
    s_add_u32 s52, s52, s57
    s_cmp_eq_u32 s51, 0
    s_movk_i32 s96, 2560
    s_cselect_b32 s96, 1280, s96
    s_cselect_b32 s57, 0, 2621440
    s_cselect_b32 s97, 1051011932, 1.0
    s_cmp_eq_u32 s51, 2
    s_cselect_b32 s58, 1280, 0
    s_cselect_b32 s98, 4, 0
    s_add_u32 s57, s57, s58
    s_lshl_b32 s58, s48, 1
    s_and_b32 s51, s3, 1
    s_add_u32 s58, s58, s51
    s_lshl_b32 s58, s58, 1
    s_mul_i32 s58, s58, s96
    s_add_u32 s100, s57, s58
    s_lshl_b32 s99, s96, 6
    v_lshrrev_b32 v1, 4, v255
    v_add_u32 v1, s52, v1
    v_and_b32 v68, 15, v255
    v_lshlrev_b32 v68, 1, v68
    v_add_u32 v69, 0, v1
    v_mul_u32_u24 v2, 209716, v69
    v_lshrrev_b32 v2, 20, v2
    v_mul_u32_u24 v3, 5, v2
    v_sub_u32 v3, v69, v3
    v_mul_lo_u32 v2, v2, s99
    v_lshl_add_u32 v2, v3, 8, v2
    v_mul_u32_u24 v3, s98, v3
    v_xor_b32 v3, v3, v68
    v_lshl_add_u32 v112, v3, 3, v2
    v_add_u32 v69, 4, v1
    v_mul_u32_u24 v2, 209716, v69
    v_lshrrev_b32 v2, 20, v2
    v_mul_u32_u24 v3, 5, v2
    v_sub_u32 v3, v69, v3
    v_mul_lo_u32 v2, v2, s99
    v_lshl_add_u32 v2, v3, 8, v2
    v_mul_u32_u24 v3, s98, v3
    v_xor_b32 v3, v3, v68
    v_lshl_add_u32 v113, v3, 3, v2
    v_add_u32 v69, 8, v1
    v_mul_u32_u24 v2, 209716, v69
    v_lshrrev_b32 v2, 20, v2
    v_mul_u32_u24 v3, 5, v2
    v_sub_u32 v3, v69, v3
    v_mul_lo_u32 v2, v2, s99
    v_lshl_add_u32 v2, v3, 8, v2
    v_mul_u32_u24 v3, s98, v3
    v_xor_b32 v3, v3, v68
    v_lshl_add_u32 v114, v3, 3, v2
    v_add_u32 v69, 12, v1
    v_mul_u32_u24 v2, 209716, v69
    v_lshrrev_b32 v2, 20, v2
    v_mul_u32_u24 v3, 5, v2
    v_sub_u32 v3, v69, v3
    v_mul_lo_u32 v2, v2, s99
    v_lshl_add_u32 v2, v3, 8, v2
    v_mul_u32_u24 v3, s98, v3
    v_xor_b32 v3, v3, v68
    v_lshl_add_u32 v115, v3, 3, v2
    s_add_u32 s44, s28, s100
    s_addc_u32 s45, s29, 0
    s_mov_b32 s46, 5242880
    s_mov_b32 s47, 0x00020000
    v_and_b32 v120, 7, v255
    v_lshlrev_b32 v120, 2, v120
    s_add_u32 s40, s28, 7864320
    s_addc_u32 s41, s29, 0
    s_mov_b32 s42, 2621440
    s_mov_b32 s43, 0x00020000
    s_lshl_b32 s51, s30, 2
    s_lshr_b32 s52, s31, 3
    s_add_u32 s51, s51, s52
    s_lshl_b32 s51, s51, 7
    s_and_b32 s52, s31, 7
    s_mul_i32 s52, s52, 327680
    s_add_u32 s93, s51, s52
    s_lshl_b32 s52, s3, 10
    v_lshlrev_b32 v1, 4, v255
    v_add_u32 v1, s52, v1
    v_add_u32 v216, 131072, v1
    v_lshrrev_b32 v2, 3, v255
    s_lshl_b32 s52, s3, 3
    v_add_u32 v2, s52, v2
    v_lshrrev_b32 v3, 1, v2
    v_xor_b32 v3, v3, v255
    v_and_b32 v3, 7, v3
    v_lshlrev_b32 v3, 4, v3
    v_lshl_add_u32 v217, v2, 12, v3
    v_add_u32 v218, 131072, v217
    s_cmp_lt_u32 s3, 2
    s_mov_b32 s52, 1074003968
    s_cselect_b32 s52, 262144, s52
    v_add_u32 v219, s52, v217
    s_waitcnt vmcnt(0)
    v_lshlrev_b32 v1, 2, v255
    v_add_u32 v1, s53, v1
    ds_read_b32 v132, v1 offset:0
    ds_read_b32 v133, v1 offset:160
    ds_read_b32 v134, v1 offset:320
    ds_read_b32 v135, v1 offset:480
    ds_read_b32 v136, v1 offset:640
    ds_read_b32 v137, v1 offset:800
    ds_read_b32 v138, v1 offset:960
    ds_read_b32 v139, v1 offset:1120
    ds_read_b32 v140, v1 offset:1280
    ds_read_b32 v141, v1 offset:1440
    ds_read_b32 v142, v1 offset:1600
    v_lshlrev_b32 v152, 16, v128
    v_lshlrev_b32 v153, 16, v130
    v_and_b32 v154, 0xffff0000, v128
    v_and_b32 v155, 0xffff0000, v130
    v_lshlrev_b32 v156, 16, v129
    v_lshlrev_b32 v157, 16, v131
    v_and_b32 v158, 0xffff0000, v129
    v_and_b32 v159, 0xffff0000, v131
    s_waitcnt lgkmcnt(0)
    ds_read_b32 v144, v1 offset:2048
    ds_read_b32 v145, v1 offset:2208
    ds_read_b32 v146, v1 offset:2368
    ds_read_b32 v147, v1 offset:2528
    ds_read_b32 v148, v1 offset:2688
    ds_read_b32 v149, v1 offset:2848
    ds_read_b32 v150, v1 offset:3008
    ds_read_b32 v151, v1 offset:3168
    v_lshlrev_b32 v160, 16, v132
    v_and_b32 v161, 0xffff0000, v132
    v_lshlrev_b32 v162, 16, v133
    v_and_b32 v163, 0xffff0000, v133
    v_lshlrev_b32 v164, 16, v134
    v_and_b32 v165, 0xffff0000, v134
    v_lshlrev_b32 v166, 16, v135
    v_and_b32 v167, 0xffff0000, v135
    v_lshlrev_b32 v168, 16, v136
    v_and_b32 v169, 0xffff0000, v136
    v_lshlrev_b32 v170, 16, v137
    v_and_b32 v171, 0xffff0000, v137
    v_lshlrev_b32 v172, 16, v138
    v_and_b32 v173, 0xffff0000, v138
    v_lshlrev_b32 v174, 16, v139
    v_and_b32 v175, 0xffff0000, v139
    v_lshlrev_b32 v176, 16, v140
    v_and_b32 v177, 0xffff0000, v140
    v_lshlrev_b32 v178, 16, v141
    v_and_b32 v179, 0xffff0000, v141
    v_lshlrev_b32 v180, 16, v142
    v_and_b32 v181, 0xffff0000, v142
    s_waitcnt lgkmcnt(0)
    v_lshlrev_b32 v182, 16, v144
    v_and_b32 v183, 0xffff0000, v144
    v_lshlrev_b32 v184, 16, v145
    v_and_b32 v185, 0xffff0000, v145
    v_lshlrev_b32 v186, 16, v146
    v_and_b32 v187, 0xffff0000, v146
    v_lshlrev_b32 v188, 16, v147
    v_and_b32 v189, 0xffff0000, v147
    v_lshlrev_b32 v190, 16, v148
    v_and_b32 v191, 0xffff0000, v148
    v_lshlrev_b32 v192, 16, v149
    v_and_b32 v193, 0xffff0000, v149
    v_lshlrev_b32 v194, 16, v150
    v_and_b32 v195, 0xffff0000, v150
    v_lshlrev_b32 v196, 16, v151
    v_and_b32 v197, 0xffff0000, v151
    v_pk_mul_f32 v[198:199], v[166:167], v[152:153]
    v_pk_fma_f32 v[198:199], v[164:165], v[154:155], v[198:199]
    v_pk_fma_f32 v[198:199], v[162:163], v[156:157], v[198:199]
    v_pk_fma_f32 v[198:199], v[160:161], v[158:159], v[198:199]
    v_pk_mul_f32 v[182:183], v[198:199], v[182:183]
    v_pk_mul_f32 v[200:201], v[168:169], v[152:153]
    v_pk_fma_f32 v[200:201], v[166:167], v[154:155], v[200:201]
    v_pk_fma_f32 v[200:201], v[164:165], v[156:157], v[200:201]
    v_pk_fma_f32 v[200:201], v[162:163], v[158:159], v[200:201]
    v_pk_mul_f32 v[184:185], v[200:201], v[184:185]
    v_pk_mul_f32 v[198:199], v[170:171], v[152:153]
    v_pk_fma_f32 v[198:199], v[168:169], v[154:155], v[198:199]
    v_pk_fma_f32 v[198:199], v[166:167], v[156:157], v[198:199]
    v_pk_fma_f32 v[198:199], v[164:165], v[158:159], v[198:199]
    v_pk_mul_f32 v[186:187], v[198:199], v[186:187]
    v_pk_mul_f32 v[200:201], v[172:173], v[152:153]
    v_pk_fma_f32 v[200:201], v[170:171], v[154:155], v[200:201]
    v_pk_fma_f32 v[200:201], v[168:169], v[156:157], v[200:201]
    v_pk_fma_f32 v[200:201], v[166:167], v[158:159], v[200:201]
    v_pk_mul_f32 v[188:189], v[200:201], v[188:189]
    v_pk_mul_f32 v[198:199], v[174:175], v[152:153]
    v_pk_fma_f32 v[198:199], v[172:173], v[154:155], v[198:199]
    v_pk_fma_f32 v[198:199], v[170:171], v[156:157], v[198:199]
    v_pk_fma_f32 v[198:199], v[168:169], v[158:159], v[198:199]
    v_pk_mul_f32 v[190:191], v[198:199], v[190:191]
    v_pk_mul_f32 v[200:201], v[176:177], v[152:153]
    v_pk_fma_f32 v[200:201], v[174:175], v[154:155], v[200:201]
    v_pk_fma_f32 v[200:201], v[172:173], v[156:157], v[200:201]
    v_pk_fma_f32 v[200:201], v[170:171], v[158:159], v[200:201]
    v_pk_mul_f32 v[192:193], v[200:201], v[192:193]
    v_pk_mul_f32 v[198:199], v[178:179], v[152:153]
    v_pk_fma_f32 v[198:199], v[176:177], v[154:155], v[198:199]
    v_pk_fma_f32 v[198:199], v[174:175], v[156:157], v[198:199]
    v_pk_fma_f32 v[198:199], v[172:173], v[158:159], v[198:199]
    v_pk_mul_f32 v[194:195], v[198:199], v[194:195]
    v_pk_mul_f32 v[200:201], v[180:181], v[152:153]
    v_pk_fma_f32 v[200:201], v[178:179], v[154:155], v[200:201]
    v_pk_fma_f32 v[200:201], v[176:177], v[156:157], v[200:201]
    v_pk_fma_f32 v[200:201], v[174:175], v[158:159], v[200:201]
    v_pk_mul_f32 v[196:197], v[200:201], v[196:197]
    v_cvt_pk_bf16_f32 v132, v196, v194
    v_cvt_pk_bf16_f32 v133, v192, v190
    v_cvt_pk_bf16_f32 v134, v188, v186
    v_cvt_pk_bf16_f32 v135, v184, v182
    v_cvt_pk_bf16_f32 v136, v197, v195
    v_cvt_pk_bf16_f32 v137, v193, v191
    v_cvt_pk_bf16_f32 v138, v189, v187
    v_cvt_pk_bf16_f32 v139, v185, v183
    v_and_b32 v2, 7, v255
    v_xor_b32 v2, s3, v2
    v_lshlrev_b32 v2, 4, v2
    v_lshl_add_u32 v2, v255, 8, v2
    v_add_u32 v3, 131072, v2
    s_mov_b32 exec_hi, 0xff
    ds_write_b128 v3, v[132:135]
    ds_write_b128 v3, v[136:139] offset:128
    s_mov_b64 exec, -1
    s_lshl_b32 s101, s49, 4
    s_add_u32 s101, s101, s48
    s_lshl_b32 s101, s101, 5
    s_add_u32 s101, s101, 8192
    s_lshl_b32 s80, s30, 2
    s_lshr_b32 s52, s31, 3
    s_add_u32 s80, s80, s52
    s_and_b32 s81, s31, 7
    s_lshr_b32 s82, s3, 2
    s_and_b32 s83, s3, 3
    s_lshl_b32 s84, s81, 3
    s_lshl_b32 s52, s83, 1
    s_add_u32 s84, s84, s52
    v_lshlrev_b32 v136, 4, v255
    s_lshl_b32 s86, s30, 2
    s_lshr_b32 s52, s31, 3
    s_add_u32 s86, s86, s52
    s_and_b32 s87, s31, 7
    s_mul_i32 s88, s82, 41216
    s_mul_i32 s52, s83, 2576
    s_add_u32 s88, s88, s52
    s_lshl_b32 s52, s83, 6
    v_add_u32 v1, s52, v255
    v_mul_u32_u24 v2, 104858, v1
    v_lshrrev_b32 v2, 20, v2
    v_mul_u32_u24 v3, 10, v2
    v_sub_u32 v3, v1, v3
    s_mul_i32 s53, s87, 160
    v_lshl_add_u32 v3, v3, 4, s53
    v_bfe_u32 v1, v2, 3, 1
    v_mul_u32_u24 v248, 20, v1
    v_bfe_u32 v1, v2, 2, 1
    v_lshl_add_u32 v248, v1, 3, v248
    v_lshrrev_b32 v1, 4, v2
    v_lshl_add_u32 v248, v1, 2, v248
    v_bfe_u32 v249, v2, 2, 2
    v_lshl_add_u32 v249, v1, 2, v249
    v_mul_u32_u24 v249, 20, v249
    v_and_b32 v1, 3, v2
    v_add_u32 v248, v248, v1
    v_add3_u32 v249, v249, v1, 16
    v_mul_u32_u24 v248, 1280, v248
    v_mul_u32_u24 v249, 1280, v249
    v_add_u32 v248, v248, v3
    v_add_u32 v249, v249, v3
    v_add_u32 v1, 256, v255
    v_mul_u32_u24 v2, 104858, v1
    v_lshrrev_b32 v2, 20, v2
    v_mul_u32_u24 v3, 10, v2
    v_sub_u32 v3, v1, v3
    s_mul_i32 s53, s87, 160
    v_lshl_add_u32 v3, v3, 4, s53
    v_bfe_u32 v1, v2, 3, 1
    v_mul_u32_u24 v246, 20, v1
    v_bfe_u32 v1, v2, 2, 1
    v_lshl_add_u32 v246, v1, 3, v246
    v_lshrrev_b32 v1, 4, v2
    v_lshl_add_u32 v246, v1, 2, v246
    v_bfe_u32 v247, v2, 2, 2
    v_lshl_add_u32 v247, v1, 2, v247
    v_mul_u32_u24 v247, 20, v247
    v_and_b32 v1, 3, v2
    v_add_u32 v246, v246, v1
    v_add3_u32 v247, v247, v1, 16
    v_mul_u32_u24 v246, 1280, v246
    v_mul_u32_u24 v247, 1280, v247
    v_add_u32 v246, v246, v3
    v_add_u32 v247, v247, v3
    s_mul_i32 s52, s87, 327680
    s_lshl_b32 s53, s86, 7
    s_add_u32 s52, s52, s53
    s_lshl_b32 s53, s83, 5
    s_add_u32 s52, s52, s53
    v_lshrrev_b32 v1, 1, v255
    v_lshl_add_u32 v1, v1, 12, s52
    v_and_b32 v2, 1, v255
    v_lshl_add_u32 v250, v2, 4, v1
    v_add_u32 v251, 131072, v250
    v_add_u32 v252, 196608, v250
    s_lshl_b32 s52, s86, 2
    s_add_u32 s52, s52, s83
    s_lshl_b32 s52, s52, 4
    v_and_b32 v1, 15, v255
    v_add_u32 v1, s52, v1
    v_lshlrev_b32 v254, 2, v1
    v_mul_u32_u24 v1, 1280, v1
    v_lshrrev_b32 v2, 4, v255
    v_lshl_add_u32 v1, v2, 3, v1
    s_mul_i32 s52, s87, 160
    s_mul_i32 s53, s82, 64
    s_add_u32 s52, s52, s53
    v_add_u32 v253, s52, v1
    s_lshl_b32 s52, s87, 5
    v_and_b32 v1, 31, v255
    v_add_u32 v1, s52, v1
    v_lshlrev_b32 v1, 5, v1
    v_add_u32 v1, 16384, v1
    s_lshr_b32 s52, s86, 1
    s_lshl_b32 s52, s52, 5
    s_add_u32 s52, s52, 15872
    v_mov_b32 v2, s52
    v_cmp_gt_u32 s[94:95], 32, v255
    s_nop 1
    v_cndmask_b32 v237, v2, v1, s[94:95]
    v_and_b32 v1, 31, v255
    v_lshl_add_u32 v1, v1, 3, s30
    v_lshlrev_b32 v1, 5, v1
    v_add_u32 v236, 16384, v1
    s_cmp_eq_u32 s83, 0
    s_cselect_b32 s90, 1114112, 0
    s_mul_i32 s91, s82, 69888
    s_or_b32 s90, s90, s91
    s_mov_b32 s91, 0
    s_mul_i32 s58, s82, 41216
    s_mul_i32 s62, s83, 2576
    s_add_u32 s62, s62, s58
    s_mul_i32 s60, s83, 2560
    v_and_b32 v1, 31, v255
    v_lshrrev_b32 v2, 5, v255
    v_lshl_add_u32 v125, v1, 3, s58
    v_lshl_add_u32 v124, v2, 9, v125
    v_and_b32 v1, 3, v255
    v_lshlrev_b32 v3, 1, v1
    v_lshrrev_b32 v144, 1, v1
    v_or_b32 v3, v3, v144
    v_and_b32 v3, 3, v3
    v_and_b32 v144, 16, v255
    v_cmp_eq_u32 s[52:53], 0, v144
    s_nop 1
    v_cndmask_b32 v3, 4, v3, s[52:53]
    v_bfe_u32 v144, v255, 2, 2
    v_lshl_add_u32 v144, v2, 2, v144
    v_lshlrev_b32 v145, 2, v3
    v_lshlrev_b32 v3, 8, v3
    v_add3_u32 v3, v3, s58, 0
    v_add_u32 v3, 1280, v3
    v_and_b32 v146, 19, v255
    v_cmp_lt_u32 s[52:53], 16, v146
    v_cmp_eq_u32 vcc, 1, v1
    v_mov_b32 v146, 2560
    v_mov_b32 v147, 2568
    v_cndmask_b32_e64 v146, v146, v147, vcc
    v_add_u32 v146, s58, v146
    v_add_u32 v147, 0, v144
    v_xor_b32 v147, v147, v145
    v_lshl_add_u32 v147, v147, 3, v3
    v_cndmask_b32 v126, v147, v146, s[52:53]
    v_add_u32 v147, 8, v144
    v_xor_b32 v147, v147, v145
    v_lshl_add_u32 v147, v147, 3, v3
    v_cndmask_b32 v127, v147, v146, s[52:53]
    v_add_u32 v147, 16, v144
    v_xor_b32 v147, v147, v145
    v_lshl_add_u32 v147, v147, 3, v3
    v_cndmask_b32 v128, v147, v146, s[52:53]
    v_add_u32 v147, 24, v144
    v_xor_b32 v147, v147, v145
    v_lshl_add_u32 v147, v147, 3, v3
    v_cndmask_b32 v129, v147, v146, s[52:53]
    s_lshl_b32 s52, s82, 2
    s_add_u32 s53, s52, 163776
    v_mov_b32 v137, s53
    s_sub_u32 s53, 163780, s52
    v_mov_b32 v131, s53
    v_mov_b32 v138, 1
    s_mov_b32 s63, 0
    s_mov_b32 s61, 0
    v_bfe_u32 v1, v255, 4, 1
    v_mul_u32_u24 v1, 20480, v1
    v_and_b32 v3, 15, v255
    v_bfe_u32 v2, v255, 1, 1
    v_xor_b32 v3, v3, v2
    v_lshrrev_b32 v2, 5, v255
    v_lshl_add_u32 v2, v2, 4, v3
    v_lshl_add_u32 v232, v2, 4, v1
    v_lshl_add_u32 v233, v3, 3, v1
    v_subrev_u32 v132, s58, v124
    v_lshrrev_b32 v2, 5, v255
    v_mul_u32_u24 v2, 768, v2
    v_add_u32 v133, v132, v2
    s_mul_i32 s52, s80, 20
    s_add_u32 s53, s52, 19
    s_lshr_b32 s52, s52, 7
    s_lshr_b32 s53, s53, 7
    s_sub_u32 s53, s53, s52
    v_bfe_u32 v1, v255, 4, 1
    v_mul_u32_u24 v1, s53, v1
    v_add_u32 v1, s52, v1
    v_lshrrev_b32 v2, 5, v255
    v_mul_u32_u24 v2, 5, v2
    v_add3_u32 v2, v2, v1, 5
    v_and_b32 v3, 15, v255
    v_lshl_add_u32 v2, v2, 4, v3
    v_lshlrev_b32 v2, 5, v2
    v_add_u32 v150, 8192, v2
    v_and_b32 v3, 7, v3
    v_cmp_lt_u32 s[94:95], 1, v3
    s_nop 1
    v_cndmask_b32 v152, 0, 1, s[94:95]
    s_lshl_b32 s52, s81, 1
    v_and_b32 v3, 1, v255
    v_add_u32 v3, s52, v3
    v_lshl_add_u32 v1, v1, 4, v3
    v_lshlrev_b32 v1, 5, v1
    v_add_u32 v151, 8192, v1
    s_cmp_eq_u32 s49, 15
    s_cbranch_scc1 F_GATE
    s_waitcnt lgkmcnt(0)
    s_barrier
    ds_read_b128 v[204:207], v216 offset:0
    ds_read_b128 v[208:211], v216 offset:4096
    ds_read_b128 v[212:215], v216 offset:8192
    ds_read_b64_tr_b16 v[68:69], v108 offset:0
    ds_read_b64_tr_b16 v[70:71], v108 offset:1024
    ds_read_b128 v[84:87], v100 offset:0
    ds_read_b64_tr_b16 v[72:73], v109 offset:0
    ds_read_b64_tr_b16 v[74:75], v109 offset:1024
    ds_read_b128 v[88:91], v101 offset:0
    ds_read_b64_tr_b16 v[76:77], v110 offset:0
    ds_read_b64_tr_b16 v[78:79], v110 offset:1024
    ds_read_b128 v[92:95], v100 offset:4096
    ds_read_b64_tr_b16 v[80:81], v111 offset:0
    ds_read_b64_tr_b16 v[82:83], v111 offset:1024
    ds_read_b128 v[96:99], v101 offset:4096
    s_waitcnt lgkmcnt(0)
    v_mfma_f32_16x16x32_bf16 v[4:7], v[68:71], v[84:87], 0
    buffer_store_dwordx4 v[204:207], v217, s[40:43], s93 offen sc1
    buffer_store_dwordx4 v[208:211], v218, s[40:43], s93 offen sc1
    buffer_store_dwordx4 v[212:215], v219, s[40:43], s93 offen sc1
    s_cmp_eq_u32 s3, 0
    s_cbranch_scc0 II_1
    buffer_load_dword v121, v120, s[36:39], 0 offen sc1
II_1:
    ds_read_b64_tr_b16 v[156:157], v108 offset:8192
    v_mfma_f32_16x16x32_bf16 v[8:11], v[68:71], v[88:91], 0
    ds_read_b64_tr_b16 v[158:159], v108 offset:9216
    v_mfma_f32_16x16x32_bf16 v[12:15], v[68:71], v[92:95], 0
    ds_read_b128 v[172:175], v102 offset:0
    v_mfma_f32_16x16x32_bf16 v[16:19], v[68:71], v[96:99], 0
    ds_read_b64_tr_b16 v[160:161], v109 offset:8192
    v_mfma_f32_16x16x32_bf16 v[20:23], v[72:75], v[84:87], 0
    ds_read_b64_tr_b16 v[162:163], v109 offset:9216
    v_mfma_f32_16x16x32_bf16 v[24:27], v[72:75], v[88:91], 0
    ds_read_b128 v[176:179], v103 offset:0
    v_mfma_f32_16x16x32_bf16 v[28:31], v[72:75], v[92:95], 0
    ds_read_b64_tr_b16 v[164:165], v110 offset:8192
    v_mfma_f32_16x16x32_bf16 v[32:35], v[72:75], v[96:99], 0
    ds_read_b64_tr_b16 v[166:167], v110 offset:9216
    v_mfma_f32_16x16x32_bf16 v[36:39], v[76:79], v[84:87], 0
    ds_read_b128 v[180:183], v102 offset:4096
    v_mfma_f32_16x16x32_bf16 v[40:43], v[76:79], v[88:91], 0
    ds_read_b64_tr_b16 v[168:169], v111 offset:8192
    v_mfma_f32_16x16x32_bf16 v[44:47], v[76:79], v[92:95], 0
    ds_read_b64_tr_b16 v[170:171], v111 offset:9216
    v_mfma_f32_16x16x32_bf16 v[48:51], v[76:79], v[96:99], 0
    ds_read_b128 v[184:187], v103 offset:4096
    v_mfma_f32_16x16x32_bf16 v[52:55], v[80:83], v[84:87], 0
    v_mfma_f32_16x16x32_bf16 v[56:59], v[80:83], v[88:91], 0
    v_mfma_f32_16x16x32_bf16 v[60:63], v[80:83], v[92:95], 0
    v_mfma_f32_16x16x32_bf16 v[64:67], v[80:83], v[96:99], 0
    s_waitcnt lgkmcnt(0)
    v_mfma_f32_16x16x32_bf16 v[4:7], v[156:159], v[172:175], v[4:7]
    s_barrier
    ds_read_b64_tr_b16 v[68:69], v108 offset:32768
    v_mfma_f32_16x16x32_bf16 v[8:11], v[156:159], v[176:179], v[8:11]
    ds_read_b64_tr_b16 v[70:71], v108 offset:33792
    v_mfma_f32_16x16x32_bf16 v[12:15], v[156:159], v[180:183], v[12:15]
    ds_read_b128 v[84:87], v100 offset:32768
    v_mfma_f32_16x16x32_bf16 v[16:19], v[156:159], v[184:187], v[16:19]
    ds_read_b64_tr_b16 v[72:73], v109 offset:32768
    v_mfma_f32_16x16x32_bf16 v[20:23], v[160:163], v[172:175], v[20:23]
    ds_read_b64_tr_b16 v[74:75], v109 offset:33792
    v_mfma_f32_16x16x32_bf16 v[24:27], v[160:163], v[176:179], v[24:27]
    ds_read_b128 v[88:91], v101 offset:32768
    v_mfma_f32_16x16x32_bf16 v[28:31], v[160:163], v[180:183], v[28:31]
    ds_read_b64_tr_b16 v[76:77], v110 offset:32768
    v_mfma_f32_16x16x32_bf16 v[32:35], v[160:163], v[184:187], v[32:35]
    ds_read_b64_tr_b16 v[78:79], v110 offset:33792
    v_mfma_f32_16x16x32_bf16 v[36:39], v[164:167], v[172:175], v[36:39]
    ds_read_b128 v[92:95], v100 offset:36864
    v_mfma_f32_16x16x32_bf16 v[40:43], v[164:167], v[176:179], v[40:43]
    ds_read_b64_tr_b16 v[80:81], v111 offset:32768
    v_mfma_f32_16x16x32_bf16 v[44:47], v[164:167], v[180:183], v[44:47]
    ds_read_b64_tr_b16 v[82:83], v111 offset:33792
    v_mfma_f32_16x16x32_bf16 v[48:51], v[164:167], v[184:187], v[48:51]
    ds_read_b128 v[96:99], v101 offset:36864
    v_mfma_f32_16x16x32_bf16 v[52:55], v[168:171], v[172:175], v[52:55]
    v_mfma_f32_16x16x32_bf16 v[56:59], v[168:171], v[176:179], v[56:59]
    v_mfma_f32_16x16x32_bf16 v[60:63], v[168:171], v[180:183], v[60:63]
    v_mfma_f32_16x16x32_bf16 v[64:67], v[168:171], v[184:187], v[64:67]
    s_waitcnt lgkmcnt(0)
    v_mfma_f32_16x16x32_bf16 v[4:7], v[68:71], v[84:87], v[4:7]
    ds_read_b64_tr_b16 v[156:157], v108 offset:40960
    v_mfma_f32_16x16x32_bf16 v[8:11], v[68:71], v[88:91], v[8:11]
    ds_read_b64_tr_b16 v[158:159], v108 offset:41984
    v_mfma_f32_16x16x32_bf16 v[12:15], v[68:71], v[92:95], v[12:15]
    ds_read_b128 v[172:175], v102 offset:32768
    v_mfma_f32_16x16x32_bf16 v[16:19], v[68:71], v[96:99], v[16:19]
    ds_read_b64_tr_b16 v[160:161], v109 offset:40960
    v_mfma_f32_16x16x32_bf16 v[20:23], v[72:75], v[84:87], v[20:23]
    ds_read_b64_tr_b16 v[162:163], v109 offset:41984
    v_mfma_f32_16x16x32_bf16 v[24:27], v[72:75], v[88:91], v[24:27]
    ds_read_b128 v[176:179], v103 offset:32768
    v_mfma_f32_16x16x32_bf16 v[28:31], v[72:75], v[92:95], v[28:31]
    ds_read_b64_tr_b16 v[164:165], v110 offset:40960
    v_mfma_f32_16x16x32_bf16 v[32:35], v[72:75], v[96:99], v[32:35]
    ds_read_b64_tr_b16 v[166:167], v110 offset:41984
    v_mfma_f32_16x16x32_bf16 v[36:39], v[76:79], v[84:87], v[36:39]
    ds_read_b128 v[180:183], v102 offset:36864
    v_mfma_f32_16x16x32_bf16 v[40:43], v[76:79], v[88:91], v[40:43]
    ds_read_b64_tr_b16 v[168:169], v111 offset:40960
    v_mfma_f32_16x16x32_bf16 v[44:47], v[76:79], v[92:95], v[44:47]
    ds_read_b64_tr_b16 v[170:171], v111 offset:41984
    v_mfma_f32_16x16x32_bf16 v[48:51], v[76:79], v[96:99], v[48:51]
    ds_read_b128 v[184:187], v103 offset:36864
    v_mfma_f32_16x16x32_bf16 v[52:55], v[80:83], v[84:87], v[52:55]
    v_mfma_f32_16x16x32_bf16 v[56:59], v[80:83], v[88:91], v[56:59]
    v_mfma_f32_16x16x32_bf16 v[60:63], v[80:83], v[92:95], v[60:63]
    v_mfma_f32_16x16x32_bf16 v[64:67], v[80:83], v[96:99], v[64:67]
    s_waitcnt lgkmcnt(0)
    v_mfma_f32_16x16x32_bf16 v[4:7], v[156:159], v[172:175], v[4:7]
    s_barrier
    ds_read_b64_tr_b16 v[68:69], v116 offset:0
    v_mfma_f32_16x16x32_bf16 v[8:11], v[156:159], v[176:179], v[8:11]
    ds_read_b64_tr_b16 v[70:71], v116 offset:1024
    v_mfma_f32_16x16x32_bf16 v[12:15], v[156:159], v[180:183], v[12:15]
    ds_read_b128 v[84:87], v104 offset:0
    v_mfma_f32_16x16x32_bf16 v[16:19], v[156:159], v[184:187], v[16:19]
    ds_read_b64_tr_b16 v[72:73], v117 offset:0
    v_mfma_f32_16x16x32_bf16 v[20:23], v[160:163], v[172:175], v[20:23]
    ds_read_b64_tr_b16 v[74:75], v117 offset:1024
    v_mfma_f32_16x16x32_bf16 v[24:27], v[160:163], v[176:179], v[24:27]
    ds_read_b128 v[88:91], v105 offset:0
    v_mfma_f32_16x16x32_bf16 v[28:31], v[160:163], v[180:183], v[28:31]
    ds_read_b64_tr_b16 v[76:77], v118 offset:0
    v_mfma_f32_16x16x32_bf16 v[32:35], v[160:163], v[184:187], v[32:35]
    ds_read_b64_tr_b16 v[78:79], v118 offset:1024
    v_mfma_f32_16x16x32_bf16 v[36:39], v[164:167], v[172:175], v[36:39]
    ds_read_b128 v[92:95], v104 offset:4096
    v_mfma_f32_16x16x32_bf16 v[40:43], v[164:167], v[176:179], v[40:43]
    ds_read_b64_tr_b16 v[80:81], v119 offset:0
    v_mfma_f32_16x16x32_bf16 v[44:47], v[164:167], v[180:183], v[44:47]
    ds_read_b64_tr_b16 v[82:83], v119 offset:1024
    v_mfma_f32_16x16x32_bf16 v[48:51], v[164:167], v[184:187], v[48:51]
    ds_read_b128 v[96:99], v105 offset:4096
    v_mfma_f32_16x16x32_bf16 v[52:55], v[168:171], v[172:175], v[52:55]
    v_mfma_f32_16x16x32_bf16 v[56:59], v[168:171], v[176:179], v[56:59]
    v_mfma_f32_16x16x32_bf16 v[60:63], v[168:171], v[180:183], v[60:63]
    v_mfma_f32_16x16x32_bf16 v[64:67], v[168:171], v[184:187], v[64:67]
    s_waitcnt lgkmcnt(0)
    v_mfma_f32_16x16x32_bf16 v[4:7], v[68:71], v[84:87], v[4:7]
    ds_read_b64_tr_b16 v[156:157], v116 offset:8192
    v_mfma_f32_16x16x32_bf16 v[8:11], v[68:71], v[88:91], v[8:11]
    ds_read_b64_tr_b16 v[158:159], v116 offset:9216
    v_mfma_f32_16x16x32_bf16 v[12:15], v[68:71], v[92:95], v[12:15]
    ds_read_b128 v[172:175], v106 offset:0
    v_mfma_f32_16x16x32_bf16 v[16:19], v[68:71], v[96:99], v[16:19]
    ds_read_b64_tr_b16 v[160:161], v117 offset:8192
    v_mfma_f32_16x16x32_bf16 v[20:23], v[72:75], v[84:87], v[20:23]
    ds_read_b64_tr_b16 v[162:163], v117 offset:9216
    v_mfma_f32_16x16x32_bf16 v[24:27], v[72:75], v[88:91], v[24:27]
    ds_read_b128 v[176:179], v107 offset:0
    v_mfma_f32_16x16x32_bf16 v[28:31], v[72:75], v[92:95], v[28:31]
    ds_read_b64_tr_b16 v[164:165], v118 offset:8192
    v_mfma_f32_16x16x32_bf16 v[32:35], v[72:75], v[96:99], v[32:35]
    ds_read_b64_tr_b16 v[166:167], v118 offset:9216
    v_mfma_f32_16x16x32_bf16 v[36:39], v[76:79], v[84:87], v[36:39]
    ds_read_b128 v[180:183], v106 offset:4096
    v_mfma_f32_16x16x32_bf16 v[40:43], v[76:79], v[88:91], v[40:43]
    ds_read_b64_tr_b16 v[168:169], v119 offset:8192
    v_mfma_f32_16x16x32_bf16 v[44:47], v[76:79], v[92:95], v[44:47]
    ds_read_b64_tr_b16 v[170:171], v119 offset:9216
    v_mfma_f32_16x16x32_bf16 v[48:51], v[76:79], v[96:99], v[48:51]
    ds_read_b128 v[184:187], v107 offset:4096
    v_mfma_f32_16x16x32_bf16 v[52:55], v[80:83], v[84:87], v[52:55]
    v_mfma_f32_16x16x32_bf16 v[56:59], v[80:83], v[88:91], v[56:59]
    v_mfma_f32_16x16x32_bf16 v[60:63], v[80:83], v[92:95], v[60:63]
    v_mfma_f32_16x16x32_bf16 v[64:67], v[80:83], v[96:99], v[64:67]
    s_waitcnt lgkmcnt(0)
    v_mfma_f32_16x16x32_bf16 v[4:7], v[156:159], v[172:175], v[4:7]
    s_waitcnt vmcnt(0)
    s_cmp_eq_u32 s3, 0
    s_cbranch_scc0 IE_2
    s_waitcnt vmcnt(0)
    v_cmp_ne_u32 s[94:95], 1, v121
    s_nop 0
    s_cmp_eq_u64 s[94:95], 0
    s_cbranch_scc1 IE_2
    s_mov_b32 s89, 400000
SP_3:
    buffer_load_dword v121, v120, s[36:39], 0 offen sc1
    s_waitcnt vmcnt(0)
    v_cmp_ne_u32 s[94:95], 1, v121
    s_nop 0
    s_cmp_eq_u64 s[94:95], 0
    s_cbranch_scc1 SE_4
    s_sub_u32 s89, s89, 1
    s_cbranch_scc0 SP_3
SE_4:
IE_2:
    s_barrier
    s_cmp_eq_u32 s3, 0
    s_cbranch_scc0 F1E_5
    s_and_b32 s51, s31, 7
    s_lshl_b32 s51, s51, 3
    s_add_u32 s51, s51, s30
    s_lshl_b32 s51, s51, 2
    s_lshr_b32 s52, s31, 3
    s_add_u32 s51, s51, s52
    s_lshl_b32 s51, s51, 5
    s_add_u32 s32, s28, 15794176
    s_addc_u32 s33, s29, 0
    s_mov_b32 s34, 24576
    s_mov_b32 s35, 0x00020000
    v_mov_b32 v1, 0
    v_mov_b32 v2, 1
    s_mov_b64 exec, 1
    buffer_store_dword v2, v1, s[32:35], s51 offen sc1
    s_mov_b64 exec, -1
F1E_5:
    ds_read_b64_tr_b16 v[68:69], v108 offset:0
    v_mfma_f32_16x16x32_bf16 v[8:11], v[156:159], v[176:179], v[8:11]
    ds_read_b64_tr_b16 v[70:71], v108 offset:1024
    v_mfma_f32_16x16x32_bf16 v[12:15], v[156:159], v[180:183], v[12:15]
    ds_read_b128 v[84:87], v100 offset:0
    v_mfma_f32_16x16x32_bf16 v[16:19], v[156:159], v[184:187], v[16:19]
    ds_read_b64_tr_b16 v[72:73], v109 offset:0
    v_mfma_f32_16x16x32_bf16 v[20:23], v[160:163], v[172:175], v[20:23]
    ds_read_b64_tr_b16 v[74:75], v109 offset:1024
    v_mfma_f32_16x16x32_bf16 v[24:27], v[160:163], v[176:179], v[24:27]
    ds_read_b128 v[88:91], v101 offset:0
    v_mfma_f32_16x16x32_bf16 v[28:31], v[160:163], v[180:183], v[28:31]
    ds_read_b64_tr_b16 v[76:77], v110 offset:0
    v_mfma_f32_16x16x32_bf16 v[32:35], v[160:163], v[184:187], v[32:35]
    ds_read_b64_tr_b16 v[78:79], v110 offset:1024
    v_mfma_f32_16x16x32_bf16 v[36:39], v[164:167], v[172:175], v[36:39]
    ds_read_b128 v[92:95], v100 offset:4096
    v_mfma_f32_16x16x32_bf16 v[40:43], v[164:167], v[176:179], v[40:43]
    ds_read_b64_tr_b16 v[80:81], v111 offset:0
    v_mfma_f32_16x16x32_bf16 v[44:47], v[164:167], v[180:183], v[44:47]
    ds_read_b64_tr_b16 v[82:83], v111 offset:1024
    v_mfma_f32_16x16x32_bf16 v[48:51], v[164:167], v[184:187], v[48:51]
    ds_read_b128 v[96:99], v101 offset:4096
    v_mfma_f32_16x16x32_bf16 v[52:55], v[168:171], v[172:175], v[52:55]
    v_mfma_f32_16x16x32_bf16 v[56:59], v[168:171], v[176:179], v[56:59]
    v_mfma_f32_16x16x32_bf16 v[60:63], v[168:171], v[180:183], v[60:63]
    v_mfma_f32_16x16x32_bf16 v[64:67], v[168:171], v[184:187], v[64:67]
    s_waitcnt lgkmcnt(0)
    v_mfma_f32_16x16x32_bf16 v[4:7], v[68:71], v[84:87], v[4:7]
    ds_read_b64_tr_b16 v[156:157], v108 offset:8192
    v_mfma_f32_16x16x32_bf16 v[8:11], v[68:71], v[88:91], v[8:11]
    ds_read_b64_tr_b16 v[158:159], v108 offset:9216
    v_mfma_f32_16x16x32_bf16 v[12:15], v[68:71], v[92:95], v[12:15]
    ds_read_b128 v[172:175], v102 offset:0
    v_mfma_f32_16x16x32_bf16 v[16:19], v[68:71], v[96:99], v[16:19]
    ds_read_b64_tr_b16 v[160:161], v109 offset:8192
    v_mfma_f32_16x16x32_bf16 v[20:23], v[72:75], v[84:87], v[20:23]
    ds_read_b64_tr_b16 v[162:163], v109 offset:9216
    v_mfma_f32_16x16x32_bf16 v[24:27], v[72:75], v[88:91], v[24:27]
    ds_read_b128 v[176:179], v103 offset:0
    v_mfma_f32_16x16x32_bf16 v[28:31], v[72:75], v[92:95], v[28:31]
    ds_read_b64_tr_b16 v[164:165], v110 offset:8192
    v_mfma_f32_16x16x32_bf16 v[32:35], v[72:75], v[96:99], v[32:35]
    ds_read_b64_tr_b16 v[166:167], v110 offset:9216
    v_mfma_f32_16x16x32_bf16 v[36:39], v[76:79], v[84:87], v[36:39]
    ds_read_b128 v[180:183], v102 offset:4096
    v_mfma_f32_16x16x32_bf16 v[40:43], v[76:79], v[88:91], v[40:43]
    ds_read_b64_tr_b16 v[168:169], v111 offset:8192
    v_mfma_f32_16x16x32_bf16 v[44:47], v[76:79], v[92:95], v[44:47]
    ds_read_b64_tr_b16 v[170:171], v111 offset:9216
    v_mfma_f32_16x16x32_bf16 v[48:51], v[76:79], v[96:99], v[48:51]
    ds_read_b128 v[184:187], v103 offset:4096
    v_mfma_f32_16x16x32_bf16 v[52:55], v[80:83], v[84:87], v[52:55]
    v_mfma_f32_16x16x32_bf16 v[56:59], v[80:83], v[88:91], v[56:59]
    v_mfma_f32_16x16x32_bf16 v[60:63], v[80:83], v[92:95], v[60:63]
    v_mfma_f32_16x16x32_bf16 v[64:67], v[80:83], v[96:99], v[64:67]
    s_waitcnt lgkmcnt(0)
    v_mfma_f32_16x16x32_bf16 v[4:7], v[156:159], v[172:175], v[4:7]
    s_barrier
    ds_read_b64_tr_b16 v[68:69], v108 offset:32768
    v_mfma_f32_16x16x32_bf16 v[8:11], v[156:159], v[176:179], v[8:11]
    ds_read_b64_tr_b16 v[70:71], v108 offset:33792
    v_mfma_f32_16x16x32_bf16 v[12:15], v[156:159], v[180:183], v[12:15]
    ds_read_b128 v[84:87], v100 offset:32768
    v_mfma_f32_16x16x32_bf16 v[16:19], v[156:159], v[184:187], v[16:19]
    ds_read_b64_tr_b16 v[72:73], v109 offset:32768
    v_mfma_f32_16x16x32_bf16 v[20:23], v[160:163], v[172:175], v[20:23]
    ds_read_b64_tr_b16 v[74:75], v109 offset:33792
    v_mfma_f32_16x16x32_bf16 v[24:27], v[160:163], v[176:179], v[24:27]
    ds_read_b128 v[88:91], v101 offset:32768
    v_mfma_f32_16x16x32_bf16 v[28:31], v[160:163], v[180:183], v[28:31]
    ds_read_b64_tr_b16 v[76:77], v110 offset:32768
    v_mfma_f32_16x16x32_bf16 v[32:35], v[160:163], v[184:187], v[32:35]
    ds_read_b64_tr_b16 v[78:79], v110 offset:33792
    v_mfma_f32_16x16x32_bf16 v[36:39], v[164:167], v[172:175], v[36:39]
    ds_read_b128 v[92:95], v100 offset:36864
    v_mfma_f32_16x16x32_bf16 v[40:43], v[164:167], v[176:179], v[40:43]
    ds_read_b64_tr_b16 v[80:81], v111 offset:32768
    v_mfma_f32_16x16x32_bf16 v[44:47], v[164:167], v[180:183], v[44:47]
    ds_read_b64_tr_b16 v[82:83], v111 offset:33792
    v_mfma_f32_16x16x32_bf16 v[48:51], v[164:167], v[184:187], v[48:51]
    ds_read_b128 v[96:99], v101 offset:36864
    v_mfma_f32_16x16x32_bf16 v[52:55], v[168:171], v[172:175], v[52:55]
    v_mfma_f32_16x16x32_bf16 v[56:59], v[168:171], v[176:179], v[56:59]
    v_mfma_f32_16x16x32_bf16 v[60:63], v[168:171], v[180:183], v[60:63]
    v_mfma_f32_16x16x32_bf16 v[64:67], v[168:171], v[184:187], v[64:67]
    s_waitcnt lgkmcnt(0)
    v_mfma_f32_16x16x32_bf16 v[4:7], v[68:71], v[84:87], v[4:7]
    ds_read_b64_tr_b16 v[156:157], v108 offset:40960
    v_mfma_f32_16x16x32_bf16 v[8:11], v[68:71], v[88:91], v[8:11]
    ds_read_b64_tr_b16 v[158:159], v108 offset:41984
    v_mfma_f32_16x16x32_bf16 v[12:15], v[68:71], v[92:95], v[12:15]
    ds_read_b128 v[172:175], v102 offset:32768
    v_mfma_f32_16x16x32_bf16 v[16:19], v[68:71], v[96:99], v[16:19]
    ds_read_b64_tr_b16 v[160:161], v109 offset:40960
    v_mfma_f32_16x16x32_bf16 v[20:23], v[72:75], v[84:87], v[20:23]
    ds_read_b64_tr_b16 v[162:163], v109 offset:41984
    v_mfma_f32_16x16x32_bf16 v[24:27], v[72:75], v[88:91], v[24:27]
    ds_read_b128 v[176:179], v103 offset:32768
    v_mfma_f32_16x16x32_bf16 v[28:31], v[72:75], v[92:95], v[28:31]
    ds_read_b64_tr_b16 v[164:165], v110 offset:40960
    v_mfma_f32_16x16x32_bf16 v[32:35], v[72:75], v[96:99], v[32:35]
    ds_read_b64_tr_b16 v[166:167], v110 offset:41984
    v_mfma_f32_16x16x32_bf16 v[36:39], v[76:79], v[84:87], v[36:39]
    ds_read_b128 v[180:183], v102 offset:36864
    v_mfma_f32_16x16x32_bf16 v[40:43], v[76:79], v[88:91], v[40:43]
    ds_read_b64_tr_b16 v[168:169], v111 offset:40960
    v_mfma_f32_16x16x32_bf16 v[44:47], v[76:79], v[92:95], v[44:47]
    ds_read_b64_tr_b16 v[170:171], v111 offset:41984
    v_mfma_f32_16x16x32_bf16 v[48:51], v[76:79], v[96:99], v[48:51]
    ds_read_b128 v[184:187], v103 offset:36864
    v_mfma_f32_16x16x32_bf16 v[52:55], v[80:83], v[84:87], v[52:55]
    v_mfma_f32_16x16x32_bf16 v[56:59], v[80:83], v[88:91], v[56:59]
    v_mfma_f32_16x16x32_bf16 v[60:63], v[80:83], v[92:95], v[60:63]
    v_mfma_f32_16x16x32_bf16 v[64:67], v[80:83], v[96:99], v[64:67]
    s_waitcnt lgkmcnt(0)
    v_mfma_f32_16x16x32_bf16 v[4:7], v[156:159], v[172:175], v[4:7]
    s_barrier
    ds_read_b64_tr_b16 v[68:69], v116 offset:0
    v_mfma_f32_16x16x32_bf16 v[8:11], v[156:159], v[176:179], v[8:11]
    ds_read_b64_tr_b16 v[70:71], v116 offset:1024
    v_mfma_f32_16x16x32_bf16 v[12:15], v[156:159], v[180:183], v[12:15]
    ds_read_b128 v[84:87], v104 offset:0
    v_mfma_f32_16x16x32_bf16 v[16:19], v[156:159], v[184:187], v[16:19]
    ds_read_b64_tr_b16 v[72:73], v117 offset:0
    v_mfma_f32_16x16x32_bf16 v[20:23], v[160:163], v[172:175], v[20:23]
    ds_read_b64_tr_b16 v[74:75], v117 offset:1024
    v_mfma_f32_16x16x32_bf16 v[24:27], v[160:163], v[176:179], v[24:27]
    ds_read_b128 v[88:91], v105 offset:0
    v_mfma_f32_16x16x32_bf16 v[28:31], v[160:163], v[180:183], v[28:31]
    ds_read_b64_tr_b16 v[76:77], v118 offset:0
    v_mfma_f32_16x16x32_bf16 v[32:35], v[160:163], v[184:187], v[32:35]
    ds_read_b64_tr_b16 v[78:79], v118 offset:1024
    v_mfma_f32_16x16x32_bf16 v[36:39], v[164:167], v[172:175], v[36:39]
    ds_read_b128 v[92:95], v104 offset:4096
    v_mfma_f32_16x16x32_bf16 v[40:43], v[164:167], v[176:179], v[40:43]
    ds_read_b64_tr_b16 v[80:81], v119 offset:0
    v_mfma_f32_16x16x32_bf16 v[44:47], v[164:167], v[180:183], v[44:47]
    ds_read_b64_tr_b16 v[82:83], v119 offset:1024
    v_mfma_f32_16x16x32_bf16 v[48:51], v[164:167], v[184:187], v[48:51]
    ds_read_b128 v[96:99], v105 offset:4096
    v_mfma_f32_16x16x32_bf16 v[52:55], v[168:171], v[172:175], v[52:55]
    v_mfma_f32_16x16x32_bf16 v[56:59], v[168:171], v[176:179], v[56:59]
    v_mfma_f32_16x16x32_bf16 v[60:63], v[168:171], v[180:183], v[60:63]
    v_mfma_f32_16x16x32_bf16 v[64:67], v[168:171], v[184:187], v[64:67]
    s_waitcnt lgkmcnt(0)
    v_mfma_f32_16x16x32_bf16 v[4:7], v[68:71], v[84:87], v[4:7]
    ds_read_b64_tr_b16 v[156:157], v116 offset:8192
    v_mfma_f32_16x16x32_bf16 v[8:11], v[68:71], v[88:91], v[8:11]
    ds_read_b64_tr_b16 v[158:159], v116 offset:9216
    v_mfma_f32_16x16x32_bf16 v[12:15], v[68:71], v[92:95], v[12:15]
    ds_read_b128 v[172:175], v106 offset:0
    v_mfma_f32_16x16x32_bf16 v[16:19], v[68:71], v[96:99], v[16:19]
    ds_read_b64_tr_b16 v[160:161], v117 offset:8192
    v_mfma_f32_16x16x32_bf16 v[20:23], v[72:75], v[84:87], v[20:23]
    ds_read_b64_tr_b16 v[162:163], v117 offset:9216
    v_mfma_f32_16x16x32_bf16 v[24:27], v[72:75], v[88:91], v[24:27]
    ds_read_b128 v[176:179], v107 offset:0
    v_mfma_f32_16x16x32_bf16 v[28:31], v[72:75], v[92:95], v[28:31]
    ds_read_b64_tr_b16 v[164:165], v118 offset:8192
    v_mfma_f32_16x16x32_bf16 v[32:35], v[72:75], v[96:99], v[32:35]
    ds_read_b64_tr_b16 v[166:167], v118 offset:9216
    v_mfma_f32_16x16x32_bf16 v[36:39], v[76:79], v[84:87], v[36:39]
    ds_read_b128 v[180:183], v106 offset:4096
    v_mfma_f32_16x16x32_bf16 v[40:43], v[76:79], v[88:91], v[40:43]
    ds_read_b64_tr_b16 v[168:169], v119 offset:8192
    v_mfma_f32_16x16x32_bf16 v[44:47], v[76:79], v[92:95], v[44:47]
    ds_read_b64_tr_b16 v[170:171], v119 offset:9216
    v_mfma_f32_16x16x32_bf16 v[48:51], v[76:79], v[96:99], v[48:51]
    ds_read_b128 v[184:187], v107 offset:4096
    v_mfma_f32_16x16x32_bf16 v[52:55], v[80:83], v[84:87], v[52:55]
    v_mfma_f32_16x16x32_bf16 v[56:59], v[80:83], v[88:91], v[56:59]
    v_mfma_f32_16x16x32_bf16 v[60:63], v[80:83], v[92:95], v[60:63]
    v_mfma_f32_16x16x32_bf16 v[64:67], v[80:83], v[96:99], v[64:67]
    s_waitcnt lgkmcnt(0)
    v_mfma_f32_16x16x32_bf16 v[4:7], v[156:159], v[172:175], v[4:7]
    s_barrier
    ds_read_b64_tr_b16 v[68:69], v108 offset:0
    v_mfma_f32_16x16x32_bf16 v[8:11], v[156:159], v[176:179], v[8:11]
    ds_read_b64_tr_b16 v[70:71], v108 offset:1024
    v_mfma_f32_16x16x32_bf16 v[12:15], v[156:159], v[180:183], v[12:15]
    ds_read_b128 v[84:87], v100 offset:0
    v_mfma_f32_16x16x32_bf16 v[16:19], v[156:159], v[184:187], v[16:19]
    ds_read_b64_tr_b16 v[72:73], v109 offset:0
    v_mfma_f32_16x16x32_bf16 v[20:23], v[160:163], v[172:175], v[20:23]
    ds_read_b64_tr_b16 v[74:75], v109 offset:1024
    v_mfma_f32_16x16x32_bf16 v[24:27], v[160:163], v[176:179], v[24:27]
    ds_read_b128 v[88:91], v101 offset:0
    v_mfma_f32_16x16x32_bf16 v[28:31], v[160:163], v[180:183], v[28:31]
    ds_read_b64_tr_b16 v[76:77], v110 offset:0
    v_mfma_f32_16x16x32_bf16 v[32:35], v[160:163], v[184:187], v[32:35]
    ds_read_b64_tr_b16 v[78:79], v110 offset:1024
    v_mfma_f32_16x16x32_bf16 v[36:39], v[164:167], v[172:175], v[36:39]
    ds_read_b128 v[92:95], v100 offset:4096
    v_mfma_f32_16x16x32_bf16 v[40:43], v[164:167], v[176:179], v[40:43]
    ds_read_b64_tr_b16 v[80:81], v111 offset:0
    v_mfma_f32_16x16x32_bf16 v[44:47], v[164:167], v[180:183], v[44:47]
    ds_read_b64_tr_b16 v[82:83], v111 offset:1024
    v_mfma_f32_16x16x32_bf16 v[48:51], v[164:167], v[184:187], v[48:51]
    ds_read_b128 v[96:99], v101 offset:4096
    v_mfma_f32_16x16x32_bf16 v[52:55], v[168:171], v[172:175], v[52:55]
    v_mfma_f32_16x16x32_bf16 v[56:59], v[168:171], v[176:179], v[56:59]
    v_mfma_f32_16x16x32_bf16 v[60:63], v[168:171], v[180:183], v[60:63]
    v_mfma_f32_16x16x32_bf16 v[64:67], v[168:171], v[184:187], v[64:67]
    s_waitcnt lgkmcnt(0)
    v_mfma_f32_16x16x32_bf16 v[4:7], v[68:71], v[84:87], v[4:7]
    ds_read_b64_tr_b16 v[156:157], v108 offset:8192
    v_mfma_f32_16x16x32_bf16 v[8:11], v[68:71], v[88:91], v[8:11]
    ds_read_b64_tr_b16 v[158:159], v108 offset:9216
    v_mfma_f32_16x16x32_bf16 v[12:15], v[68:71], v[92:95], v[12:15]
    ds_read_b128 v[172:175], v102 offset:0
    v_mfma_f32_16x16x32_bf16 v[16:19], v[68:71], v[96:99], v[16:19]
    ds_read_b64_tr_b16 v[160:161], v109 offset:8192
    v_mfma_f32_16x16x32_bf16 v[20:23], v[72:75], v[84:87], v[20:23]
    ds_read_b64_tr_b16 v[162:163], v109 offset:9216
    v_mfma_f32_16x16x32_bf16 v[24:27], v[72:75], v[88:91], v[24:27]
    ds_read_b128 v[176:179], v103 offset:0
    v_mfma_f32_16x16x32_bf16 v[28:31], v[72:75], v[92:95], v[28:31]
    ds_read_b64_tr_b16 v[164:165], v110 offset:8192
    v_mfma_f32_16x16x32_bf16 v[32:35], v[72:75], v[96:99], v[32:35]
    ds_read_b64_tr_b16 v[166:167], v110 offset:9216
    v_mfma_f32_16x16x32_bf16 v[36:39], v[76:79], v[84:87], v[36:39]
    ds_read_b128 v[180:183], v102 offset:4096
    v_mfma_f32_16x16x32_bf16 v[40:43], v[76:79], v[88:91], v[40:43]
    ds_read_b64_tr_b16 v[168:169], v111 offset:8192
    v_mfma_f32_16x16x32_bf16 v[44:47], v[76:79], v[92:95], v[44:47]
    ds_read_b64_tr_b16 v[170:171], v111 offset:9216
    v_mfma_f32_16x16x32_bf16 v[48:51], v[76:79], v[96:99], v[48:51]
    ds_read_b128 v[184:187], v103 offset:4096
    v_mfma_f32_16x16x32_bf16 v[52:55], v[80:83], v[84:87], v[52:55]
    v_mfma_f32_16x16x32_bf16 v[56:59], v[80:83], v[88:91], v[56:59]
    v_mfma_f32_16x16x32_bf16 v[60:63], v[80:83], v[92:95], v[60:63]
    v_mfma_f32_16x16x32_bf16 v[64:67], v[80:83], v[96:99], v[64:67]
    s_waitcnt lgkmcnt(0)
    v_mfma_f32_16x16x32_bf16 v[4:7], v[156:159], v[172:175], v[4:7]
    s_barrier
    ds_read_b64_tr_b16 v[68:69], v108 offset:32768
    v_mfma_f32_16x16x32_bf16 v[8:11], v[156:159], v[176:179], v[8:11]
    ds_read_b64_tr_b16 v[70:71], v108 offset:33792
    v_mfma_f32_16x16x32_bf16 v[12:15], v[156:159], v[180:183], v[12:15]
    ds_read_b128 v[84:87], v100 offset:32768
    v_mfma_f32_16x16x32_bf16 v[16:19], v[156:159], v[184:187], v[16:19]
    ds_read_b64_tr_b16 v[72:73], v109 offset:32768
    v_mfma_f32_16x16x32_bf16 v[20:23], v[160:163], v[172:175], v[20:23]
    ds_read_b64_tr_b16 v[74:75], v109 offset:33792
    v_mfma_f32_16x16x32_bf16 v[24:27], v[160:163], v[176:179], v[24:27]
    ds_read_b128 v[88:91], v101 offset:32768
    v_mfma_f32_16x16x32_bf16 v[28:31], v[160:163], v[180:183], v[28:31]
    ds_read_b64_tr_b16 v[76:77], v110 offset:32768
    v_mfma_f32_16x16x32_bf16 v[32:35], v[160:163], v[184:187], v[32:35]
    ds_read_b64_tr_b16 v[78:79], v110 offset:33792
    v_mfma_f32_16x16x32_bf16 v[36:39], v[164:167], v[172:175], v[36:39]
    ds_read_b128 v[92:95], v100 offset:36864
    v_mfma_f32_16x16x32_bf16 v[40:43], v[164:167], v[176:179], v[40:43]
    ds_read_b64_tr_b16 v[80:81], v111 offset:32768
    v_mfma_f32_16x16x32_bf16 v[44:47], v[164:167], v[180:183], v[44:47]
    ds_read_b64_tr_b16 v[82:83], v111 offset:33792
    v_mfma_f32_16x16x32_bf16 v[48:51], v[164:167], v[184:187], v[48:51]
    ds_read_b128 v[96:99], v101 offset:36864
    v_mfma_f32_16x16x32_bf16 v[52:55], v[168:171], v[172:175], v[52:55]
    v_mfma_f32_16x16x32_bf16 v[56:59], v[168:171], v[176:179], v[56:59]
    v_mfma_f32_16x16x32_bf16 v[60:63], v[168:171], v[180:183], v[60:63]
    v_mfma_f32_16x16x32_bf16 v[64:67], v[168:171], v[184:187], v[64:67]
    s_waitcnt lgkmcnt(0)
    v_mfma_f32_16x16x32_bf16 v[4:7], v[68:71], v[84:87], v[4:7]
    ds_read_b64_tr_b16 v[156:157], v108 offset:40960
    v_mfma_f32_16x16x32_bf16 v[8:11], v[68:71], v[88:91], v[8:11]
    ds_read_b64_tr_b16 v[158:159], v108 offset:41984
    v_mfma_f32_16x16x32_bf16 v[12:15], v[68:71], v[92:95], v[12:15]
    ds_read_b128 v[172:175], v102 offset:32768
    v_mfma_f32_16x16x32_bf16 v[16:19], v[68:71], v[96:99], v[16:19]
    ds_read_b64_tr_b16 v[160:161], v109 offset:40960
    v_mfma_f32_16x16x32_bf16 v[20:23], v[72:75], v[84:87], v[20:23]
    ds_read_b64_tr_b16 v[162:163], v109 offset:41984
    v_mfma_f32_16x16x32_bf16 v[24:27], v[72:75], v[88:91], v[24:27]
    ds_read_b128 v[176:179], v103 offset:32768
    v_mfma_f32_16x16x32_bf16 v[28:31], v[72:75], v[92:95], v[28:31]
    ds_read_b64_tr_b16 v[164:165], v110 offset:40960
    v_mfma_f32_16x16x32_bf16 v[32:35], v[72:75], v[96:99], v[32:35]
    ds_read_b64_tr_b16 v[166:167], v110 offset:41984
    v_mfma_f32_16x16x32_bf16 v[36:39], v[76:79], v[84:87], v[36:39]
    ds_read_b128 v[180:183], v102 offset:36864
    v_mfma_f32_16x16x32_bf16 v[40:43], v[76:79], v[88:91], v[40:43]
    ds_read_b64_tr_b16 v[168:169], v111 offset:40960
    v_mfma_f32_16x16x32_bf16 v[44:47], v[76:79], v[92:95], v[44:47]
    ds_read_b64_tr_b16 v[170:171], v111 offset:41984
    v_mfma_f32_16x16x32_bf16 v[48:51], v[76:79], v[96:99], v[48:51]
    ds_read_b128 v[184:187], v103 offset:36864
    v_mfma_f32_16x16x32_bf16 v[52:55], v[80:83], v[84:87], v[52:55]
    v_mfma_f32_16x16x32_bf16 v[56:59], v[80:83], v[88:91], v[56:59]
    v_mfma_f32_16x16x32_bf16 v[60:63], v[80:83], v[92:95], v[60:63]
    v_mfma_f32_16x16x32_bf16 v[64:67], v[80:83], v[96:99], v[64:67]
    s_waitcnt lgkmcnt(0)
    v_mfma_f32_16x16x32_bf16 v[4:7], v[156:159], v[172:175], v[4:7]
    s_barrier
    ds_read_b64_tr_b16 v[68:69], v116 offset:0
    v_mfma_f32_16x16x32_bf16 v[8:11], v[156:159], v[176:179], v[8:11]
    ds_read_b64_tr_b16 v[70:71], v116 offset:1024
    v_mfma_f32_16x16x32_bf16 v[12:15], v[156:159], v[180:183], v[12:15]
    ds_read_b128 v[84:87], v104 offset:0
    v_mfma_f32_16x16x32_bf16 v[16:19], v[156:159], v[184:187], v[16:19]
    ds_read_b64_tr_b16 v[72:73], v117 offset:0
    v_mfma_f32_16x16x32_bf16 v[20:23], v[160:163], v[172:175], v[20:23]
    ds_read_b64_tr_b16 v[74:75], v117 offset:1024
    v_mfma_f32_16x16x32_bf16 v[24:27], v[160:163], v[176:179], v[24:27]
    ds_read_b128 v[88:91], v105 offset:0
    v_mfma_f32_16x16x32_bf16 v[28:31], v[160:163], v[180:183], v[28:31]
    ds_read_b64_tr_b16 v[76:77], v118 offset:0
    v_mfma_f32_16x16x32_bf16 v[32:35], v[160:163], v[184:187], v[32:35]
    ds_read_b64_tr_b16 v[78:79], v118 offset:1024
    v_mfma_f32_16x16x32_bf16 v[36:39], v[164:167], v[172:175], v[36:39]
    ds_read_b128 v[92:95], v104 offset:4096
    v_mfma_f32_16x16x32_bf16 v[40:43], v[164:167], v[176:179], v[40:43]
    ds_read_b64_tr_b16 v[80:81], v119 offset:0
    v_mfma_f32_16x16x32_bf16 v[44:47], v[164:167], v[180:183], v[44:47]
    ds_read_b64_tr_b16 v[82:83], v119 offset:1024
    v_mfma_f32_16x16x32_bf16 v[48:51], v[164:167], v[184:187], v[48:51]
    ds_read_b128 v[96:99], v105 offset:4096
    v_mfma_f32_16x16x32_bf16 v[52:55], v[168:171], v[172:175], v[52:55]
    v_mfma_f32_16x16x32_bf16 v[56:59], v[168:171], v[176:179], v[56:59]
    v_mfma_f32_16x16x32_bf16 v[60:63], v[168:171], v[180:183], v[60:63]
    v_mfma_f32_16x16x32_bf16 v[64:67], v[168:171], v[184:187], v[64:67]
    s_waitcnt lgkmcnt(0)
    v_mfma_f32_16x16x32_bf16 v[4:7], v[68:71], v[84:87], v[4:7]
    ds_read_b64_tr_b16 v[156:157], v116 offset:8192
    v_mfma_f32_16x16x32_bf16 v[8:11], v[68:71], v[88:91], v[8:11]
    ds_read_b64_tr_b16 v[158:159], v116 offset:9216
    v_mfma_f32_16x16x32_bf16 v[12:15], v[68:71], v[92:95], v[12:15]
    ds_read_b128 v[172:175], v106 offset:0
    v_mfma_f32_16x16x32_bf16 v[16:19], v[68:71], v[96:99], v[16:19]
    ds_read_b64_tr_b16 v[160:161], v117 offset:8192
    v_mfma_f32_16x16x32_bf16 v[20:23], v[72:75], v[84:87], v[20:23]
    ds_read_b64_tr_b16 v[162:163], v117 offset:9216
    v_mfma_f32_16x16x32_bf16 v[24:27], v[72:75], v[88:91], v[24:27]
    ds_read_b128 v[176:179], v107 offset:0
    v_mfma_f32_16x16x32_bf16 v[28:31], v[72:75], v[92:95], v[28:31]
    ds_read_b64_tr_b16 v[164:165], v118 offset:8192
    v_mfma_f32_16x16x32_bf16 v[32:35], v[72:75], v[96:99], v[32:35]
    ds_read_b64_tr_b16 v[166:167], v118 offset:9216
    v_mfma_f32_16x16x32_bf16 v[36:39], v[76:79], v[84:87], v[36:39]
    ds_read_b128 v[180:183], v106 offset:4096
    v_mfma_f32_16x16x32_bf16 v[40:43], v[76:79], v[88:91], v[40:43]
    ds_read_b64_tr_b16 v[168:169], v119 offset:8192
    v_mfma_f32_16x16x32_bf16 v[44:47], v[76:79], v[92:95], v[44:47]
    ds_read_b64_tr_b16 v[170:171], v119 offset:9216
    v_mfma_f32_16x16x32_bf16 v[48:51], v[76:79], v[96:99], v[48:51]
    ds_read_b128 v[184:187], v107 offset:4096
    v_mfma_f32_16x16x32_bf16 v[52:55], v[80:83], v[84:87], v[52:55]
    v_mfma_f32_16x16x32_bf16 v[56:59], v[80:83], v[88:91], v[56:59]
    v_mfma_f32_16x16x32_bf16 v[60:63], v[80:83], v[92:95], v[60:63]
    v_mfma_f32_16x16x32_bf16 v[64:67], v[80:83], v[96:99], v[64:67]
    s_waitcnt lgkmcnt(0)
    v_mfma_f32_16x16x32_bf16 v[4:7], v[156:159], v[172:175], v[4:7]
    s_barrier
    ds_read_b64_tr_b16 v[68:69], v108 offset:0
    v_mfma_f32_16x16x32_bf16 v[8:11], v[156:159], v[176:179], v[8:11]
    ds_read_b64_tr_b16 v[70:71], v108 offset:1024
    v_mfma_f32_16x16x32_bf16 v[12:15], v[156:159], v[180:183], v[12:15]
    ds_read_b128 v[84:87], v100 offset:0
    v_mfma_f32_16x16x32_bf16 v[16:19], v[156:159], v[184:187], v[16:19]
    ds_read_b64_tr_b16 v[72:73], v109 offset:0
    v_mfma_f32_16x16x32_bf16 v[20:23], v[160:163], v[172:175], v[20:23]
    ds_read_b64_tr_b16 v[74:75], v109 offset:1024
    v_mfma_f32_16x16x32_bf16 v[24:27], v[160:163], v[176:179], v[24:27]
    ds_read_b128 v[88:91], v101 offset:0
    v_mfma_f32_16x16x32_bf16 v[28:31], v[160:163], v[180:183], v[28:31]
    ds_read_b64_tr_b16 v[76:77], v110 offset:0
    v_mfma_f32_16x16x32_bf16 v[32:35], v[160:163], v[184:187], v[32:35]
    ds_read_b64_tr_b16 v[78:79], v110 offset:1024
    v_mfma_f32_16x16x32_bf16 v[36:39], v[164:167], v[172:175], v[36:39]
    ds_read_b128 v[92:95], v100 offset:4096
    v_mfma_f32_16x16x32_bf16 v[40:43], v[164:167], v[176:179], v[40:43]
    ds_read_b64_tr_b16 v[80:81], v111 offset:0
    v_mfma_f32_16x16x32_bf16 v[44:47], v[164:167], v[180:183], v[44:47]
    ds_read_b64_tr_b16 v[82:83], v111 offset:1024
    v_mfma_f32_16x16x32_bf16 v[48:51], v[164:167], v[184:187], v[48:51]
    ds_read_b128 v[96:99], v101 offset:4096
    v_mfma_f32_16x16x32_bf16 v[52:55], v[168:171], v[172:175], v[52:55]
    v_mfma_f32_16x16x32_bf16 v[56:59], v[168:171], v[176:179], v[56:59]
    v_mfma_f32_16x16x32_bf16 v[60:63], v[168:171], v[180:183], v[60:63]
    v_mfma_f32_16x16x32_bf16 v[64:67], v[168:171], v[184:187], v[64:67]
    s_waitcnt lgkmcnt(0)
    v_mfma_f32_16x16x32_bf16 v[4:7], v[68:71], v[84:87], v[4:7]
    ds_read_b64_tr_b16 v[156:157], v108 offset:8192
    v_mfma_f32_16x16x32_bf16 v[8:11], v[68:71], v[88:91], v[8:11]
    ds_read_b64_tr_b16 v[158:159], v108 offset:9216
    v_mfma_f32_16x16x32_bf16 v[12:15], v[68:71], v[92:95], v[12:15]
    ds_read_b128 v[172:175], v102 offset:0
    v_mfma_f32_16x16x32_bf16 v[16:19], v[68:71], v[96:99], v[16:19]
    ds_read_b64_tr_b16 v[160:161], v109 offset:8192
    v_mfma_f32_16x16x32_bf16 v[20:23], v[72:75], v[84:87], v[20:23]
    ds_read_b64_tr_b16 v[162:163], v109 offset:9216
    v_mfma_f32_16x16x32_bf16 v[24:27], v[72:75], v[88:91], v[24:27]
    ds_read_b128 v[176:179], v103 offset:0
    v_mfma_f32_16x16x32_bf16 v[28:31], v[72:75], v[92:95], v[28:31]
    ds_read_b64_tr_b16 v[164:165], v110 offset:8192
    v_mfma_f32_16x16x32_bf16 v[32:35], v[72:75], v[96:99], v[32:35]
    ds_read_b64_tr_b16 v[166:167], v110 offset:9216
    v_mfma_f32_16x16x32_bf16 v[36:39], v[76:79], v[84:87], v[36:39]
    ds_read_b128 v[180:183], v102 offset:4096
    v_mfma_f32_16x16x32_bf16 v[40:43], v[76:79], v[88:91], v[40:43]
    ds_read_b64_tr_b16 v[168:169], v111 offset:8192
    v_mfma_f32_16x16x32_bf16 v[44:47], v[76:79], v[92:95], v[44:47]
    ds_read_b64_tr_b16 v[170:171], v111 offset:9216
    v_mfma_f32_16x16x32_bf16 v[48:51], v[76:79], v[96:99], v[48:51]
    ds_read_b128 v[184:187], v103 offset:4096
    v_mfma_f32_16x16x32_bf16 v[52:55], v[80:83], v[84:87], v[52:55]
    v_mfma_f32_16x16x32_bf16 v[56:59], v[80:83], v[88:91], v[56:59]
    v_mfma_f32_16x16x32_bf16 v[60:63], v[80:83], v[92:95], v[60:63]
    v_mfma_f32_16x16x32_bf16 v[64:67], v[80:83], v[96:99], v[64:67]
    s_waitcnt lgkmcnt(0)
    s_cmp_lt_u32 s49, 5
    s_cbranch_scc1 PA_EPIQ
    v_mfma_f32_16x16x32_bf16 v[4:7], v[156:159], v[172:175], v[4:7]
    v_mfma_f32_16x16x32_bf16 v[8:11], v[156:159], v[176:179], v[8:11]
    v_mfma_f32_16x16x32_bf16 v[12:15], v[156:159], v[180:183], v[12:15]
    v_mfma_f32_16x16x32_bf16 v[16:19], v[156:159], v[184:187], v[16:19]
    v_mfma_f32_16x16x32_bf16 v[20:23], v[160:163], v[172:175], v[20:23]
    v_mfma_f32_16x16x32_bf16 v[24:27], v[160:163], v[176:179], v[24:27]
    v_mfma_f32_16x16x32_bf16 v[28:31], v[160:163], v[180:183], v[28:31]
    v_mfma_f32_16x16x32_bf16 v[32:35], v[160:163], v[184:187], v[32:35]
    s_nop 0
    v_cvt_pk_bf16_f32 v68, v4, v5
    v_cvt_pk_bf16_f32 v69, v6, v7
    v_cvt_pk_bf16_f32 v70, v8, v9
    v_cvt_pk_bf16_f32 v71, v10, v11
    buffer_store_dwordx4 v[68:71], v112, s[44:47], 0 offen sc1
    v_mfma_f32_16x16x32_bf16 v[36:39], v[164:167], v[172:175], v[36:39]
    v_mfma_f32_16x16x32_bf16 v[40:43], v[164:167], v[176:179], v[40:43]
    v_cvt_pk_bf16_f32 v72, v12, v13
    v_cvt_pk_bf16_f32 v73, v14, v15
    v_cvt_pk_bf16_f32 v74, v16, v17
    v_cvt_pk_bf16_f32 v75, v18, v19
    buffer_store_dwordx4 v[72:75], v112, s[44:47], s96 offen sc1
    v_mfma_f32_16x16x32_bf16 v[44:47], v[164:167], v[180:183], v[44:47]
    v_mfma_f32_16x16x32_bf16 v[48:51], v[164:167], v[184:187], v[48:51]
    v_cvt_pk_bf16_f32 v76, v20, v21
    v_cvt_pk_bf16_f32 v77, v22, v23
    v_cvt_pk_bf16_f32 v78, v24, v25
    v_cvt_pk_bf16_f32 v79, v26, v27
    buffer_store_dwordx4 v[76:79], v113, s[44:47], 0 offen sc1
    v_mfma_f32_16x16x32_bf16 v[52:55], v[168:171], v[172:175], v[52:55]
    v_mfma_f32_16x16x32_bf16 v[56:59], v[168:171], v[176:179], v[56:59]
    v_cvt_pk_bf16_f32 v80, v28, v29
    v_cvt_pk_bf16_f32 v81, v30, v31
    v_cvt_pk_bf16_f32 v82, v32, v33
    v_cvt_pk_bf16_f32 v83, v34, v35
    buffer_store_dwordx4 v[80:83], v113, s[44:47], s96 offen sc1
    v_mfma_f32_16x16x32_bf16 v[60:63], v[168:171], v[180:183], v[60:63]
    v_mfma_f32_16x16x32_bf16 v[64:67], v[168:171], v[184:187], v[64:67]
    v_cvt_pk_bf16_f32 v84, v36, v37
    v_cvt_pk_bf16_f32 v85, v38, v39
    v_cvt_pk_bf16_f32 v86, v40, v41
    v_cvt_pk_bf16_f32 v87, v42, v43
    buffer_store_dwordx4 v[84:87], v114, s[44:47], 0 offen sc1
    v_cvt_pk_bf16_f32 v88, v44, v45
    v_cvt_pk_bf16_f32 v89, v46, v47
    v_cvt_pk_bf16_f32 v90, v48, v49
    v_cvt_pk_bf16_f32 v91, v50, v51
    buffer_store_dwordx4 v[88:91], v114, s[44:47], s96 offen sc1
    v_cvt_pk_bf16_f32 v92, v52, v53
    v_cvt_pk_bf16_f32 v93, v54, v55
    v_cvt_pk_bf16_f32 v94, v56, v57
    v_cvt_pk_bf16_f32 v95, v58, v59
    buffer_store_dwordx4 v[92:95], v115, s[44:47], 0 offen sc1
    v_cvt_pk_bf16_f32 v96, v60, v61
    v_cvt_pk_bf16_f32 v97, v62, v63
    v_cvt_pk_bf16_f32 v98, v64, v65
    v_cvt_pk_bf16_f32 v99, v66, v67
    buffer_store_dwordx4 v[96:99], v115, s[44:47], s96 offen sc1
    s_branch PA_EPID
PA_EPIQ:
    v_mfma_f32_16x16x32_bf16 v[4:7], v[156:159], v[172:175], v[4:7]
    v_mfma_f32_16x16x32_bf16 v[8:11], v[156:159], v[176:179], v[8:11]
    v_mfma_f32_16x16x32_bf16 v[12:15], v[156:159], v[180:183], v[12:15]
    v_mfma_f32_16x16x32_bf16 v[16:19], v[156:159], v[184:187], v[16:19]
    v_mfma_f32_16x16x32_bf16 v[20:23], v[160:163], v[172:175], v[20:23]
    v_mfma_f32_16x16x32_bf16 v[24:27], v[160:163], v[176:179], v[24:27]
    v_mfma_f32_16x16x32_bf16 v[28:31], v[160:163], v[180:183], v[28:31]
    v_mfma_f32_16x16x32_bf16 v[32:35], v[160:163], v[184:187], v[32:35]
    s_nop 0
    v_mul_f32 v4, s97, v4
    v_mul_f32 v5, s97, v5
    v_mul_f32 v6, s97, v6
    v_mul_f32 v7, s97, v7
    v_mul_f32 v8, s97, v8
    v_mul_f32 v9, s97, v9
    v_mul_f32 v10, s97, v10
    v_mul_f32 v11, s97, v11
    v_cvt_pk_bf16_f32 v68, v4, v5
    v_cvt_pk_bf16_f32 v69, v6, v7
    v_cvt_pk_bf16_f32 v70, v8, v9
    v_cvt_pk_bf16_f32 v71, v10, v11
    buffer_store_dwordx4 v[68:71], v112, s[44:47], 0 offen sc1
    v_mfma_f32_16x16x32_bf16 v[36:39], v[164:167], v[172:175], v[36:39]
    v_mfma_f32_16x16x32_bf16 v[40:43], v[164:167], v[176:179], v[40:43]
    v_mul_f32 v12, s97, v12
    v_mul_f32 v13, s97, v13
    v_mul_f32 v14, s97, v14
    v_mul_f32 v15, s97, v15
    v_mul_f32 v16, s97, v16
    v_mul_f32 v17, s97, v17
    v_mul_f32 v18, s97, v18
    v_mul_f32 v19, s97, v19
    v_cvt_pk_bf16_f32 v72, v12, v13
    v_cvt_pk_bf16_f32 v73, v14, v15
    v_cvt_pk_bf16_f32 v74, v16, v17
    v_cvt_pk_bf16_f32 v75, v18, v19
    buffer_store_dwordx4 v[72:75], v112, s[44:47], s96 offen sc1
    v_mfma_f32_16x16x32_bf16 v[44:47], v[164:167], v[180:183], v[44:47]
    v_mfma_f32_16x16x32_bf16 v[48:51], v[164:167], v[184:187], v[48:51]
    v_mul_f32 v20, s97, v20
    v_mul_f32 v21, s97, v21
    v_mul_f32 v22, s97, v22
    v_mul_f32 v23, s97, v23
    v_mul_f32 v24, s97, v24
    v_mul_f32 v25, s97, v25
    v_mul_f32 v26, s97, v26
    v_mul_f32 v27, s97, v27
    v_cvt_pk_bf16_f32 v76, v20, v21
    v_cvt_pk_bf16_f32 v77, v22, v23
    v_cvt_pk_bf16_f32 v78, v24, v25
    v_cvt_pk_bf16_f32 v79, v26, v27
    buffer_store_dwordx4 v[76:79], v113, s[44:47], 0 offen sc1
    v_mfma_f32_16x16x32_bf16 v[52:55], v[168:171], v[172:175], v[52:55]
    v_mfma_f32_16x16x32_bf16 v[56:59], v[168:171], v[176:179], v[56:59]
    v_mul_f32 v28, s97, v28
    v_mul_f32 v29, s97, v29
    v_mul_f32 v30, s97, v30
    v_mul_f32 v31, s97, v31
    v_mul_f32 v32, s97, v32
    v_mul_f32 v33, s97, v33
    v_mul_f32 v34, s97, v34
    v_mul_f32 v35, s97, v35
    v_cvt_pk_bf16_f32 v80, v28, v29
    v_cvt_pk_bf16_f32 v81, v30, v31
    v_cvt_pk_bf16_f32 v82, v32, v33
    v_cvt_pk_bf16_f32 v83, v34, v35
    buffer_store_dwordx4 v[80:83], v113, s[44:47], s96 offen sc1
    v_mfma_f32_16x16x32_bf16 v[60:63], v[168:171], v[180:183], v[60:63]
    v_mfma_f32_16x16x32_bf16 v[64:67], v[168:171], v[184:187], v[64:67]
    v_mul_f32 v36, s97, v36
    v_mul_f32 v37, s97, v37
    v_mul_f32 v38, s97, v38
    v_mul_f32 v39, s97, v39
    v_mul_f32 v40, s97, v40
    v_mul_f32 v41, s97, v41
    v_mul_f32 v42, s97, v42
    v_mul_f32 v43, s97, v43
    v_cvt_pk_bf16_f32 v84, v36, v37
    v_cvt_pk_bf16_f32 v85, v38, v39
    v_cvt_pk_bf16_f32 v86, v40, v41
    v_cvt_pk_bf16_f32 v87, v42, v43
    buffer_store_dwordx4 v[84:87], v114, s[44:47], 0 offen sc1
    v_mul_f32 v44, s97, v44
    v_mul_f32 v45, s97, v45
    v_mul_f32 v46, s97, v46
    v_mul_f32 v47, s97, v47
    v_mul_f32 v48, s97, v48
    v_mul_f32 v49, s97, v49
    v_mul_f32 v50, s97, v50
    v_mul_f32 v51, s97, v51
    v_cvt_pk_bf16_f32 v88, v44, v45
    v_cvt_pk_bf16_f32 v89, v46, v47
    v_cvt_pk_bf16_f32 v90, v48, v49
    v_cvt_pk_bf16_f32 v91, v50, v51
    buffer_store_dwordx4 v[88:91], v114, s[44:47], s96 offen sc1
    v_mul_f32 v52, s97, v52
    v_mul_f32 v53, s97, v53
    v_mul_f32 v54, s97, v54
    v_mul_f32 v55, s97, v55
    v_mul_f32 v56, s97, v56
    v_mul_f32 v57, s97, v57
    v_mul_f32 v58, s97, v58
    v_mul_f32 v59, s97, v59
    v_cvt_pk_bf16_f32 v92, v52, v53
    v_cvt_pk_bf16_f32 v93, v54, v55
    v_cvt_pk_bf16_f32 v94, v56, v57
    v_cvt_pk_bf16_f32 v95, v58, v59
    buffer_store_dwordx4 v[92:95], v115, s[44:47], 0 offen sc1
    v_mul_f32 v60, s97, v60
    v_mul_f32 v61, s97, v61
    v_mul_f32 v62, s97, v62
    v_mul_f32 v63, s97, v63
    v_mul_f32 v64, s97, v64
    v_mul_f32 v65, s97, v65
    v_mul_f32 v66, s97, v66
    v_mul_f32 v67, s97, v67
    v_cvt_pk_bf16_f32 v96, v60, v61
    v_cvt_pk_bf16_f32 v97, v62, v63
    v_cvt_pk_bf16_f32 v98, v64, v65
    v_cvt_pk_bf16_f32 v99, v66, v67
    buffer_store_dwordx4 v[96:99], v115, s[44:47], s96 offen sc1
PA_EPID:
    s_branch F_CDONE
F_GATE:
    s_add_u32 s50, s48, s49
    s_and_b32 s50, s50, 1
    s_mul_i32 s50, s50, 5
    v_lshrrev_b32 v1, 4, v255
    v_lshlrev_b32 v1, 4, v1
    v_add_u32 v112, 160000, v1
    s_and_b32 s51, s3, 2
    s_lshl_b32 s51, s51, 11
    v_add_u32 v100, s51, v100
    v_add_u32 v101, s51, v101
    v_add_u32 v102, s51, v102
    v_add_u32 v103, s51, v103
    v_add_u32 v104, s51, v104
    v_add_u32 v105, s51, v105
    v_add_u32 v106, s51, v106
    v_add_u32 v107, s51, v107
    s_lshl_b32 s51, s50, 7
    v_add_u32 v113, s51, v112
    s_add_u32 s50, s50, 1
    s_cmp_eq_u32 s50, 10
    s_cselect_b32 s50, 0, s50
    s_waitcnt lgkmcnt(0)
    s_barrier
    ds_read_b128 v[204:207], v216 offset:0
    ds_read_b128 v[208:211], v216 offset:4096
    ds_read_b128 v[212:215], v216 offset:8192
    ds_read_b128 v[68:71], v113 offset:0
    ds_read_b128 v[84:87], v100 offset:0
    ds_read_b128 v[88:91], v101 offset:0
    ds_read_b128 v[72:75], v113 offset:64
    ds_read_b128 v[92:95], v102 offset:0
    ds_read_b128 v[96:99], v103 offset:0
    s_waitcnt lgkmcnt(0)
    buffer_store_dwordx4 v[204:207], v217, s[40:43], s93 offen sc1
    buffer_store_dwordx4 v[208:211], v218, s[40:43], s93 offen sc1
    buffer_store_dwordx4 v[212:215], v219, s[40:43], s93 offen sc1
    s_cmp_eq_u32 s3, 0
    s_cbranch_scc0 II_6
    buffer_load_dword v121, v120, s[36:39], 0 offen sc1
II_6:
    v_mfma_f32_16x16x32_bf16 v[4:7], v[68:71], v[84:87], 0
    v_mfma_f32_16x16x32_bf16 v[8:11], v[68:71], v[88:91], 0
    v_mfma_f32_16x16x32_bf16 v[4:7], v[72:75], v[92:95], v[4:7]
    v_mfma_f32_16x16x32_bf16 v[8:11], v[72:75], v[96:99], v[8:11]
    s_lshl_b32 s51, s50, 7
    v_add_u32 v113, s51, v112
    s_add_u32 s50, s50, 1
    s_cmp_eq_u32 s50, 10
    s_cselect_b32 s50, 0, s50
    s_barrier
    ds_read_b128 v[68:71], v113 offset:0
    ds_read_b128 v[84:87], v100 offset:32768
    ds_read_b128 v[88:91], v101 offset:32768
    ds_read_b128 v[72:75], v113 offset:64
    ds_read_b128 v[92:95], v102 offset:32768
    ds_read_b128 v[96:99], v103 offset:32768
    s_waitcnt lgkmcnt(0)
    v_mfma_f32_16x16x32_bf16 v[4:7], v[68:71], v[84:87], v[4:7]
    v_mfma_f32_16x16x32_bf16 v[8:11], v[68:71], v[88:91], v[8:11]
    v_mfma_f32_16x16x32_bf16 v[4:7], v[72:75], v[92:95], v[4:7]
    v_mfma_f32_16x16x32_bf16 v[8:11], v[72:75], v[96:99], v[8:11]
    s_lshl_b32 s51, s50, 7
    v_add_u32 v113, s51, v112
    s_add_u32 s50, s50, 1
    s_cmp_eq_u32 s50, 10
    s_cselect_b32 s50, 0, s50
    s_barrier
    ds_read_b128 v[68:71], v113 offset:0
    ds_read_b128 v[84:87], v104 offset:0
    ds_read_b128 v[88:91], v105 offset:0
    ds_read_b128 v[72:75], v113 offset:64
    ds_read_b128 v[92:95], v106 offset:0
    ds_read_b128 v[96:99], v107 offset:0
    s_waitcnt lgkmcnt(0)
    v_mfma_f32_16x16x32_bf16 v[4:7], v[68:71], v[84:87], v[4:7]
    v_mfma_f32_16x16x32_bf16 v[8:11], v[68:71], v[88:91], v[8:11]
    v_mfma_f32_16x16x32_bf16 v[4:7], v[72:75], v[92:95], v[4:7]
    v_mfma_f32_16x16x32_bf16 v[8:11], v[72:75], v[96:99], v[8:11]
    s_lshl_b32 s51, s50, 7
    v_add_u32 v113, s51, v112
    s_add_u32 s50, s50, 1
    s_cmp_eq_u32 s50, 10
    s_cselect_b32 s50, 0, s50
    s_waitcnt vmcnt(0)
    s_cmp_eq_u32 s3, 0
    s_cbranch_scc0 IE_7
    s_waitcnt vmcnt(0)
    v_cmp_ne_u32 s[94:95], 1, v121
    s_nop 0
    s_cmp_eq_u64 s[94:95], 0
    s_cbranch_scc1 IE_7
    s_mov_b32 s89, 400000
SP_8:
    buffer_load_dword v121, v120, s[36:39], 0 offen sc1
    s_waitcnt vmcnt(0)
    v_cmp_ne_u32 s[94:95], 1, v121
    s_nop 0
    s_cmp_eq_u64 s[94:95], 0
    s_cbranch_scc1 SE_9
    s_sub_u32 s89, s89, 1
    s_cbranch_scc0 SP_8
SE_9:
IE_7:
    s_barrier
    s_cmp_eq_u32 s3, 0
    s_cbranch_scc0 F1E_10
    s_and_b32 s51, s31, 7
    s_lshl_b32 s51, s51, 3
    s_add_u32 s51, s51, s30
    s_lshl_b32 s51, s51, 2
    s_lshr_b32 s52, s31, 3
    s_add_u32 s51, s51, s52
    s_lshl_b32 s51, s51, 5
    s_add_u32 s32, s28, 15794176
    s_addc_u32 s33, s29, 0
    s_mov_b32 s34, 24576
    s_mov_b32 s35, 0x00020000
    v_mov_b32 v1, 0
    v_mov_b32 v2, 1
    s_mov_b64 exec, 1
    buffer_store_dword v2, v1, s[32:35], s51 offen sc1
    s_mov_b64 exec, -1
F1E_10:
    ds_read_b128 v[68:71], v113 offset:0
    ds_read_b128 v[84:87], v100 offset:0
    ds_read_b128 v[88:91], v101 offset:0
    ds_read_b128 v[72:75], v113 offset:64
    ds_read_b128 v[92:95], v102 offset:0
    ds_read_b128 v[96:99], v103 offset:0
    s_waitcnt lgkmcnt(0)
    v_mfma_f32_16x16x32_bf16 v[4:7], v[68:71], v[84:87], v[4:7]
    v_mfma_f32_16x16x32_bf16 v[8:11], v[68:71], v[88:91], v[8:11]
    v_mfma_f32_16x16x32_bf16 v[4:7], v[72:75], v[92:95], v[4:7]
    v_mfma_f32_16x16x32_bf16 v[8:11], v[72:75], v[96:99], v[8:11]
    s_lshl_b32 s51, s50, 7
    v_add_u32 v113, s51, v112
    s_add_u32 s50, s50, 1
    s_cmp_eq_u32 s50, 10
    s_cselect_b32 s50, 0, s50
    s_barrier
    ds_read_b128 v[68:71], v113 offset:0
    ds_read_b128 v[84:87], v100 offset:32768
    ds_read_b128 v[88:91], v101 offset:32768
    ds_read_b128 v[72:75], v113 offset:64
    ds_read_b128 v[92:95], v102 offset:32768
    ds_read_b128 v[96:99], v103 offset:32768
    s_waitcnt lgkmcnt(0)
    v_mfma_f32_16x16x32_bf16 v[4:7], v[68:71], v[84:87], v[4:7]
    v_mfma_f32_16x16x32_bf16 v[8:11], v[68:71], v[88:91], v[8:11]
    v_mfma_f32_16x16x32_bf16 v[4:7], v[72:75], v[92:95], v[4:7]
    v_mfma_f32_16x16x32_bf16 v[8:11], v[72:75], v[96:99], v[8:11]
    s_lshl_b32 s51, s50, 7
    v_add_u32 v113, s51, v112
    s_add_u32 s50, s50, 1
    s_cmp_eq_u32 s50, 10
    s_cselect_b32 s50, 0, s50
    s_barrier
    ds_read_b128 v[68:71], v113 offset:0
    ds_read_b128 v[84:87], v104 offset:0
    ds_read_b128 v[88:91], v105 offset:0
    ds_read_b128 v[72:75], v113 offset:64
    ds_read_b128 v[92:95], v106 offset:0
    ds_read_b128 v[96:99], v107 offset:0
    s_waitcnt lgkmcnt(0)
    v_mfma_f32_16x16x32_bf16 v[4:7], v[68:71], v[84:87], v[4:7]
    v_mfma_f32_16x16x32_bf16 v[8:11], v[68:71], v[88:91], v[8:11]
    v_mfma_f32_16x16x32_bf16 v[4:7], v[72:75], v[92:95], v[4:7]
    v_mfma_f32_16x16x32_bf16 v[8:11], v[72:75], v[96:99], v[8:11]
    s_lshl_b32 s51, s50, 7
    v_add_u32 v113, s51, v112
    s_add_u32 s50, s50, 1
    s_cmp_eq_u32 s50, 10
    s_cselect_b32 s50, 0, s50
    s_barrier
    ds_read_b128 v[68:71], v113 offset:0
    ds_read_b128 v[84:87], v100 offset:0
    ds_read_b128 v[88:91], v101 offset:0
    ds_read_b128 v[72:75], v113 offset:64
    ds_read_b128 v[92:95], v102 offset:0
    ds_read_b128 v[96:99], v103 offset:0
    s_waitcnt lgkmcnt(0)
    v_mfma_f32_16x16x32_bf16 v[4:7], v[68:71], v[84:87], v[4:7]
    v_mfma_f32_16x16x32_bf16 v[8:11], v[68:71], v[88:91], v[8:11]
    v_mfma_f32_16x16x32_bf16 v[4:7], v[72:75], v[92:95], v[4:7]
    v_mfma_f32_16x16x32_bf16 v[8:11], v[72:75], v[96:99], v[8:11]
    s_lshl_b32 s51, s50, 7
    v_add_u32 v113, s51, v112
    s_add_u32 s50, s50, 1
    s_cmp_eq_u32 s50, 10
    s_cselect_b32 s50, 0, s50
    s_barrier
    ds_read_b128 v[68:71], v113 offset:0
    ds_read_b128 v[84:87], v100 offset:32768
    ds_read_b128 v[88:91], v101 offset:32768
    ds_read_b128 v[72:75], v113 offset:64
    ds_read_b128 v[92:95], v102 offset:32768
    ds_read_b128 v[96:99], v103 offset:32768
    s_waitcnt lgkmcnt(0)
    v_mfma_f32_16x16x32_bf16 v[4:7], v[68:71], v[84:87], v[4:7]
    v_mfma_f32_16x16x32_bf16 v[8:11], v[68:71], v[88:91], v[8:11]
    v_mfma_f32_16x16x32_bf16 v[4:7], v[72:75], v[92:95], v[4:7]
    v_mfma_f32_16x16x32_bf16 v[8:11], v[72:75], v[96:99], v[8:11]
    s_lshl_b32 s51, s50, 7
    v_add_u32 v113, s51, v112
    s_add_u32 s50, s50, 1
    s_cmp_eq_u32 s50, 10
    s_cselect_b32 s50, 0, s50
    s_barrier
    ds_read_b128 v[68:71], v113 offset:0
    ds_read_b128 v[84:87], v104 offset:0
    ds_read_b128 v[88:91], v105 offset:0
    ds_read_b128 v[72:75], v113 offset:64
    ds_read_b128 v[92:95], v106 offset:0
    ds_read_b128 v[96:99], v107 offset:0
    s_waitcnt lgkmcnt(0)
    v_mfma_f32_16x16x32_bf16 v[4:7], v[68:71], v[84:87], v[4:7]
    v_mfma_f32_16x16x32_bf16 v[8:11], v[68:71], v[88:91], v[8:11]
    v_mfma_f32_16x16x32_bf16 v[4:7], v[72:75], v[92:95], v[4:7]
    v_mfma_f32_16x16x32_bf16 v[8:11], v[72:75], v[96:99], v[8:11]
    s_lshl_b32 s51, s50, 7
    v_add_u32 v113, s51, v112
    s_add_u32 s50, s50, 1
    s_cmp_eq_u32 s50, 10
    s_cselect_b32 s50, 0, s50
    s_barrier
    ds_read_b128 v[68:71], v113 offset:0
    ds_read_b128 v[84:87], v100 offset:0
    ds_read_b128 v[88:91], v101 offset:0
    ds_read_b128 v[72:75], v113 offset:64
    ds_read_b128 v[92:95], v102 offset:0
    ds_read_b128 v[96:99], v103 offset:0
    s_waitcnt lgkmcnt(0)
    v_mfma_f32_16x16x32_bf16 v[4:7], v[68:71], v[84:87], v[4:7]
    v_mfma_f32_16x16x32_bf16 v[8:11], v[68:71], v[88:91], v[8:11]
    v_mfma_f32_16x16x32_bf16 v[4:7], v[72:75], v[92:95], v[4:7]
    v_mfma_f32_16x16x32_bf16 v[8:11], v[72:75], v[96:99], v[8:11]
    s_add_u32 s44, s28, 15728640
    s_addc_u32 s45, s29, 0
    s_mov_b32 s46, 8192
    s_mov_b32 s47, 0x00020000
    s_lshl_b32 s51, s48, 9
    s_and_b32 s52, s3, 1
    s_lshl_b32 s52, s52, 8
    s_add_u32 s51, s51, s52
    s_and_b32 s52, s3, 2
    s_lshl_b32 s52, s52, 6
    s_add_u32 s51, s51, s52
    v_and_b32 v2, 15, v255
    v_bfe_u32 v3, v255, 4, 1
    v_cmp_eq_u32 s[94:95], 1, v3
    v_xor_b32 v3, v3, v255
    v_and_b32 v3, 1, v3
    v_lshl_add_u32 v2, v2, 1, v3
    v_lshlrev_b32 v2, 2, v2
    v_cndmask_b32 v1, v4, v8, s[94:95]
    v_mul_f32 v1, 0xbfb8aa3b, v1
    v_exp_f32 v1, v1
    s_nop 0
    v_add_f32 v1, 1.0, v1
    v_rcp_f32 v1, v1
    s_mov_b32 exec_hi, 0
    buffer_store_dword v1, v2, s[44:47], s51 offen sc1
    s_mov_b64 exec, -1
F_CDONE:
    s_mul_i32 s52, s80, 163840
    s_mul_i32 s53, s82, 81920
    s_add_u32 s52, s52, s53
    s_add_u32 s52, s52, 2621440
    s_add_u32 s32, s28, s52
    s_addc_u32 s33, s29, 0
    s_mov_b32 s34, 81920
    s_mov_b32 s35, 0x00020000
    s_add_u32 s36, s28, 13107200
    s_addc_u32 s37, s29, 0
    s_mov_b32 s38, 2621440
    s_mov_b32 s39, 0x00020000
    s_add_u32 s52, s84, s82
    s_mul_i32 s52, s52, 40960
    s_lshl_b32 s48, s80, 9
    s_add_u32 s48, s48, s52
    s_lshl_b32 s49, s80, 7
    s_add_u32 s49, s49, s52
    s_add_u32 s49, s49, 16384
    s_mov_b32 s50, 0
    v_mov_b32 v4, 0
    v_mov_b32 v5, 0
    v_mov_b32 v6, 0
    v_mov_b32 v7, 0
    v_mov_b32 v8, 0
    v_mov_b32 v9, 0
    v_mov_b32 v10, 0
    v_mov_b32 v11, 0
    v_mov_b32 v12, 0
    v_mov_b32 v13, 0
    v_mov_b32 v14, 0
    v_mov_b32 v15, 0
    v_mov_b32 v16, 0
    v_mov_b32 v17, 0
    v_mov_b32 v18, 0
    v_mov_b32 v19, 0
    v_mov_b32 v20, 0
    v_mov_b32 v21, 0
    v_mov_b32 v22, 0
    v_mov_b32 v23, 0
    v_mov_b32 v24, 0
    v_mov_b32 v25, 0
    v_mov_b32 v26, 0
    v_mov_b32 v27, 0
    v_mov_b32 v28, 0
    v_mov_b32 v29, 0
    v_mov_b32 v30, 0
    v_mov_b32 v31, 0
    v_mov_b32 v32, 0
    v_mov_b32 v33, 0
    v_mov_b32 v34, 0
    v_mov_b32 v35, 0
    v_mov_b32 v76, 0
    v_mov_b32 v77, 0
    v_mov_b32 v78, 0
    v_mov_b32 v79, 0
    v_mov_b32 v80, 0
    v_mov_b32 v81, 0
    v_mov_b32 v82, 0
    v_mov_b32 v83, 0
    v_mov_b32 v116, 0
    v_mov_b32 v117, 0
    v_mov_b32 v118, 0
    v_mov_b32 v119, 0
    v_mov_b32 v120, 0
    v_mov_b32 v121, 0
    v_mov_b32 v122, 0
    v_mov_b32 v123, 0
    v_mov_b32 v88, 0
    v_mov_b32 v89, 0
    v_mov_b32 v94, 0
    v_mov_b32 v95, 0
    s_waitcnt vmcnt(0)
    v_mov_b32 v1, 163788
    v_mov_b32 v2, 1
    s_mov_b64 exec, 1
    ds_add_rtn_u32 v3, v1, v2
    s_mov_b64 exec, -1
    s_waitcnt lgkmcnt(0)
    v_readfirstlane_b32 s52, v3
    s_nop 0
    s_mov_b32 s93, s52
    s_cmp_eq_u32 s93, 3
    s_cbranch_scc0 F_NOF2
    s_add_u32 s44, s28, 15794176
    s_addc_u32 s45, s29, 0
    s_mov_b32 s46, 24576
    s_mov_b32 s47, 0x00020000
    v_mov_b32 v1, 0
    v_mov_b32 v2, 1
    s_mov_b64 exec, 1
    buffer_store_dword v2, v1, s[44:47], s101 offen sc1
    s_mov_b64 exec, -1
F_NOF2:
    s_mul_i32 s52, s80, 81920
    s_mul_i32 s53, s84, 1280
    s_add_u32 s52, s52, s53
    s_add_u32 s40, s28, s52
    s_addc_u32 s41, s29, 0
    s_mov_b32 s42, 2560
    s_mov_b32 s43, 0x00020000
    s_setprio 0
    s_lshl_b32 s52, s82, 13
    v_add_u32 v216, s52, v136
    v_add_u32 v218, 4096, v216
    v_lshlrev_b32 v1, 3, v255
    v_and_b32 v2, 15, v255
    s_lshl_b32 s52, s82, 11
    s_add_u32 s52, s52, 16384
    v_add_u32 v217, s52, v1
    v_lshrrev_b32 v1, 2, v255
    v_mul_u32_u24 v1, 160, v1
    v_and_b32 v2, 3, v255
    v_lshl_add_u32 v1, v2, 3, v1
    s_mul_i32 s52, s82, 35840
    s_add_u32 s52, s52, 82432
    v_add_u32 v210, s52, v1
    s_mul_i32 s52, s82, 15360
    s_add_u32 s52, s52, 10304
    v_add_u32 v211, s52, v1
    s_lshl_b32 s52, s82, 10
    s_add_u32 s52, s52, s88
    v_lshl_add_u32 v212, v255, 3, s52
    s_mul_i32 s52, s83, 5120
    s_add_u32 s52, s52, 61760
    v_add_u32 v213, s52, v136
    v_and_b32 v2, 15, v255
    s_mov_b32 s57, 41216
    s_mul_i32 s52, s3, 5376
    s_add_u32 s52, s52, 41216
    s_cmp_eq_u32 s3, 7
    s_cselect_b32 s52, 0, s52
    v_and_b32 v1, 15, v255
    v_mul_u32_u24 v1, 336, v1
    v_lshrrev_b32 v2, 4, v255
    v_lshl_add_u32 v1, v2, 4, v1
    v_add_u32 v215, s52, v1
    s_lshl_b32 s53, s3, 6
    v_add_u32 v1, s53, v255
    v_mul_u32_u24 v2, 104858, v1
    v_lshrrev_b32 v2, 20, v2
    v_mul_u32_u24 v3, 10, v2
    v_sub_u32 v3, v1, v3
    v_mul_u32_u24 v1, 1280, v2
    v_lshl_add_u32 v220, v3, 4, v1
    v_and_b32 v1, 15, v2
    v_mul_u32_u24 v1, 336, v1
    v_lshl_add_u32 v1, v3, 5, v1
    v_lshrrev_b32 v2, 4, v2
    v_mul_u32_u24 v3, 5376, v2
    v_add3_u32 v221, v1, v3, s57
    v_add_u32 v3, 21504, v221
    v_cmp_eq_u32 s[94:95], 3, v2
    s_nop 1
    v_cndmask_b32 v222, v3, v1, s[94:95]
    v_add_u32 v1, s53, v255
    v_add_u32 v1, 512, v1
    v_mul_u32_u24 v2, 104858, v1
    v_lshrrev_b32 v2, 20, v2
    v_mul_u32_u24 v3, 10, v2
    v_sub_u32 v3, v1, v3
    v_mul_u32_u24 v1, 1280, v2
    v_lshl_add_u32 v223, v3, 4, v1
    v_and_b32 v1, 15, v2
    v_mul_u32_u24 v1, 336, v1
    v_lshl_add_u32 v1, v3, 5, v1
    v_lshrrev_b32 v2, 4, v2
    v_mul_u32_u24 v3, 5376, v2
    v_add3_u32 v224, v1, v3, s57
    v_add_u32 v3, 21504, v224
    v_cmp_eq_u32 s[94:95], 3, v2
    s_nop 1
    v_cndmask_b32 v225, v3, v1, s[94:95]
    s_cmp_ge_u32 s93, 3
    s_cbranch_scc0 F_CWAIT
    s_mov_b32 s89, 400000
F_P2A:
    buffer_load_dword v148, v150, s[44:47], 0 offen sc1
    buffer_load_dword v149, v151, s[44:47], 0 offen sc1
    s_waitcnt vmcnt(0)
    v_or_b32 v153, v148, v152
    v_and_b32 v153, v153, v149
    v_cmp_ne_u32 s[94:95], 1, v153
    s_nop 0
    s_cmp_eq_u64 s[94:95], 0
    s_cbranch_scc1 F_P2B
    s_sub_u32 s89, s89, 1
    s_cbranch_scc0 F_P2A
F_P2B:
    v_mov_b32 v1, 163792
    v_mov_b32 v2, 1
    s_mov_b64 exec, 1
    ds_add_u32 v1, v2
    s_mov_b64 exec, -1
    s_add_u32 m0, s62, 0
    s_nop 0
    buffer_load_dwordx4 v136, s[32:35], s60 offen sc1 lds
    buffer_load_dwordx4 v136, s[32:35], s60 offen offset:1024 sc1 lds
    buffer_load_dwordx4 v136, s[32:35], s60 offen offset:1536 sc1 lds
    s_add_u32 s60, s60, 10240
    buffer_load_dwordx2 v[84:85], v132, s[40:43], 0 offen offset:0 sc1
    buffer_load_dwordx2 v[86:87], v132, s[40:43], 0 offen offset:256 sc1
    buffer_load_dwordx2 v[90:91], v132, s[40:43], 0 offen offset:1280 sc1
    buffer_load_dwordx2 v[92:93], v132, s[40:43], 0 offen offset:1536 sc1
    s_mov_b32 exec_hi, 0
    buffer_load_dwordx2 v[88:89], v132, s[40:43], 0 offen offset:1024 sc1
    buffer_load_dwordx2 v[94:95], v132, s[40:43], 0 offen offset:2304 sc1
    s_mov_b64 exec, -1
    s_add_u32 m0, s62, 10304
    s_nop 0
    buffer_load_dwordx4 v136, s[32:35], s60 offen sc1 lds
    buffer_load_dwordx4 v136, s[32:35], s60 offen offset:1024 sc1 lds
    buffer_load_dwordx4 v136, s[32:35], s60 offen offset:1536 sc1 lds
    s_add_u32 s60, s60, 10240
    v_mov_b32 v140, 0x3f80
    v_mov_b32 v141, 0
    v_mov_b32 v142, 0
    v_mov_b32 v143, 0
    v_mov_b32 v1, s62
    s_mov_b64 exec, 1
    ds_write_b128 v1, v[140:143] offset:2560
    ds_write_b128 v1, v[140:143] offset:12864
    ds_write_b128 v1, v[140:143] offset:23168
    ds_write_b128 v1, v[140:143] offset:33472
    s_mov_b64 exec, -1
    v_and_b32 v148, v148, v149
    v_cmp_ne_u32 s[94:95], 1, v148
    s_nop 0
    s_cmp_eq_u64 s[94:95], 0
    s_cbranch_scc1 F_CGO
    s_mov_b32 s89, 400000
SP_11:
    buffer_load_dword v148, v150, s[44:47], 0 offen sc1
    buffer_load_dword v149, v151, s[44:47], 0 offen sc1
    s_waitcnt vmcnt(0)
    v_and_b32 v148, v148, v149
    v_cmp_ne_u32 s[94:95], 1, v148
    s_nop 0
    s_cmp_eq_u64 s[94:95], 0
    s_cbranch_scc1 SE_12
    s_sub_u32 s89, s89, 1
    s_cbranch_scc0 SP_11
SE_12:
    s_branch F_CGO
F_CWAIT:
    v_mov_b32 v1, 163792
    s_mov_b32 s89, 20000000
LW_13:
    ds_read_b32 v2, v1
    s_sub_u32 s89, s89, 1
    s_cbranch_scc1 LE_14
    s_waitcnt lgkmcnt(0)
    v_readfirstlane_b32 s52, v2
    s_nop 0
    s_cmp_ge_u32 s52, 1
    s_cbranch_scc0 LW_13
LE_14:
    s_add_u32 m0, s62, 0
    s_nop 0
    buffer_load_dwordx4 v136, s[32:35], s60 offen sc1 lds
    buffer_load_dwordx4 v136, s[32:35], s60 offen offset:1024 sc1 lds
    buffer_load_dwordx4 v136, s[32:35], s60 offen offset:1536 sc1 lds
    s_add_u32 s60, s60, 10240
    buffer_load_dwordx2 v[84:85], v132, s[40:43], 0 offen offset:0 sc1
    buffer_load_dwordx2 v[86:87], v132, s[40:43], 0 offen offset:256 sc1
    buffer_load_dwordx2 v[90:91], v132, s[40:43], 0 offen offset:1280 sc1
    buffer_load_dwordx2 v[92:93], v132, s[40:43], 0 offen offset:1536 sc1
    s_mov_b32 exec_hi, 0
    buffer_load_dwordx2 v[88:89], v132, s[40:43], 0 offen offset:1024 sc1
    buffer_load_dwordx2 v[94:95], v132, s[40:43], 0 offen offset:2304 sc1
    s_mov_b64 exec, -1
    s_add_u32 m0, s62, 10304
    s_nop 0
    buffer_load_dwordx4 v136, s[32:35], s60 offen sc1 lds
    buffer_load_dwordx4 v136, s[32:35], s60 offen offset:1024 sc1 lds
    buffer_load_dwordx4 v136, s[32:35], s60 offen offset:1536 sc1 lds
    s_add_u32 s60, s60, 10240
    v_mov_b32 v140, 0x3f80
    v_mov_b32 v141, 0
    v_mov_b32 v142, 0
    v_mov_b32 v143, 0
    v_mov_b32 v1, s62
    s_mov_b64 exec, 1
    ds_write_b128 v1, v[140:143] offset:2560
    ds_write_b128 v1, v[140:143] offset:12864
    ds_write_b128 v1, v[140:143] offset:23168
    ds_write_b128 v1, v[140:143] offset:33472
    s_mov_b64 exec, -1
F_CGO:
    s_waitcnt vmcnt(0) lgkmcnt(0)
    v_mov_b32 v1, 163796
    v_mov_b32 v2, 1
    s_mov_b64 exec, 1
    ds_add_u32 v1, v2
    s_mov_b64 exec, -1
    v_mov_b32 v1, 163796
    s_mov_b32 s89, 20000000
LW_15:
    ds_read_b32 v2, v1
    s_sub_u32 s89, s89, 1
    s_cbranch_scc1 LE_16
    s_waitcnt lgkmcnt(0)
    v_readfirstlane_b32 s52, v2
    s_nop 0
    s_cmp_ge_u32 s52, 4
    s_cbranch_scc0 LW_15
LE_16:
    s_branch F_ATT
F_H:
    s_sub_u32 s56, s3, 4
    v_lshrrev_b32 v1, 3, v255
    v_lshrrev_b32 v2, 4, v255
    v_xor_b32 v2, v2, v255
    v_and_b32 v2, 7, v2
    s_lshl_b32 s51, s56, 5
    v_add_u32 v1, s51, v1
    v_mul_u32_u24 v1, 1280, v1
    v_xor_b32 v3, 0, v2
    v_lshl_add_u32 v3, v3, 4, v1
    v_add_u32 v4, 0, v3
    v_xor_b32 v3, 4, v2
    v_lshl_add_u32 v3, v3, 4, v1
    v_add_u32 v5, 10240, v3
    v_xor_b32 v3, 0, v2
    v_lshl_add_u32 v3, v3, 4, v1
    v_add_u32 v6, 20480, v3
    v_xor_b32 v3, 4, v2
    v_lshl_add_u32 v3, v3, 4, v1
    v_add_u32 v7, 30720, v3
    v_lshrrev_b32 v1, 4, v255
    v_lshlrev_b32 v2, 2, v1
    v_xor_b32 v2, v2, v255
    v_and_b32 v2, 15, v2
    s_lshl_b32 s51, s56, 4
    v_add_u32 v1, s51, v1
    v_mul_u32_u24 v1, 3840, v1
    v_lshl_add_u32 v1, v2, 4, v1
    v_add_u32 v8, 0, v1
    v_add_u32 v9, 15360, v1
    v_add_u32 v10, 30720, v1
    v_xor_b32 v10, 32, v10
    v_add_u32 v11, 46080, v1
    v_xor_b32 v11, 32, v11
    s_add_u32 s50, s48, s49
    s_and_b32 s50, s50, 1
    s_mul_i32 s50, s50, 5
    s_lshl_b32 s59, s56, 12
    s_waitcnt lgkmcnt(0)
    s_mov_b32 s40, s12
    s_mov_b32 s41, s13
    s_mov_b32 s42, 2621440
    s_mov_b32 s43, 0x00020000
    s_mov_b32 m0, s53
    s_mov_b32 s44, s14
    s_mov_b32 s45, s15
    s_mov_b32 s46, 2621440
    s_mov_b32 s47, 0x00020000
    buffer_load_dwordx4 v14, s[40:43], 0 offen nt lds
    s_add_u32 m0, s53, 1024
    s_mov_b32 exec_hi, 0x3fff
    buffer_load_dwordx4 v15, s[40:43], 0 offen nt lds
    s_add_u32 m0, s53, 2048
    s_mov_b64 exec, -1
    buffer_load_dwordx4 v12, s[44:47], 0 offen nt lds
    s_add_u32 m0, s53, 3072
    s_mov_b64 exec, 0xffff
    buffer_load_dwordx4 v13, s[44:47], 0 offen nt lds
    s_mov_b64 exec, -1
    s_mov_b32 s40, s16
    s_mov_b32 s41, s17
    s_mov_b32 s42, 5120
    s_mov_b32 s43, 0x00020000
    s_and_b32 s52, s31, 7
    s_mul_i32 s57, s52, 640
    v_lshlrev_b32 v1, 4, v255
    buffer_load_dwordx4 v[20:23], v1, s[40:43], s57 offen
    s_lshl_b32 s53, s3, 12
    s_add_u32 s53, s53, 98304
    s_mov_b32 s32, s4
    s_mov_b32 s33, s5
    s_mov_b32 s34, 2621440
    s_mov_b32 s35, 0x00020000
    s_mov_b32 s36, s6
    s_mov_b32 s37, s7
    s_mov_b32 s38, 2457600
    s_mov_b32 s39, 0x00020000
    s_cmp_eq_u32 s49, 15
    s_cselect_b32 s38, 0, s38
F_H2:
    s_mul_i32 s54, s48, 163840
    s_lshl_b32 s51, s50, 7
    s_add_u32 s54, s54, s51
    s_mul_i32 s55, s50, 245760
    s_lshl_b32 s51, s49, 8
    s_add_u32 s55, s55, s51
    s_add_u32 m0, s59, 0
    s_nop 0
    buffer_load_dwordx4 v4, s[32:35], s54 offen  lds
    s_add_u32 m0, s59, 16384
    s_nop 0
    buffer_load_dwordx4 v8, s[36:39], s55 offen  lds
    s_add_u32 m0, s59, 1024
    s_nop 0
    buffer_load_dwordx4 v5, s[32:35], s54 offen  lds
    s_add_u32 m0, s59, 17408
    s_nop 0
    buffer_load_dwordx4 v9, s[36:39], s55 offen  lds
    s_add_u32 m0, s59, 2048
    s_nop 0
    buffer_load_dwordx4 v6, s[32:35], s54 offen  lds
    s_add_u32 m0, s59, 18432
    s_nop 0
    buffer_load_dwordx4 v10, s[36:39], s55 offen  lds
    s_add_u32 m0, s59, 3072
    s_nop 0
    buffer_load_dwordx4 v7, s[32:35], s54 offen  lds
    s_add_u32 m0, s59, 19456
    s_nop 0
    buffer_load_dwordx4 v11, s[36:39], s55 offen  lds
    s_add_u32 s50, s50, 1
    s_cmp_eq_u32 s50, 10
    s_cselect_b32 s50, 0, s50
    s_mul_i32 s54, s48, 163840
    s_lshl_b32 s51, s50, 7
    s_add_u32 s54, s54, s51
    s_mul_i32 s55, s50, 245760
    s_lshl_b32 s51, s49, 8
    s_add_u32 s55, s55, s51
    s_add_u32 m0, s59, 32768
    s_nop 0
    buffer_load_dwordx4 v4, s[32:35], s54 offen  lds
    s_add_u32 m0, s59, 49152
    s_nop 0
    buffer_load_dwordx4 v8, s[36:39], s55 offen  lds
    s_add_u32 m0, s59, 33792
    s_nop 0
    buffer_load_dwordx4 v5, s[32:35], s54 offen  lds
    s_add_u32 m0, s59, 50176
    s_nop 0
    buffer_load_dwordx4 v9, s[36:39], s55 offen  lds
    s_add_u32 m0, s59, 34816
    s_nop 0
    buffer_load_dwordx4 v6, s[32:35], s54 offen  lds
    s_add_u32 m0, s59, 51200
    s_nop 0
    buffer_load_dwordx4 v10, s[36:39], s55 offen  lds
    s_add_u32 m0, s59, 35840
    s_nop 0
    buffer_load_dwordx4 v7, s[32:35], s54 offen  lds
    s_add_u32 m0, s59, 52224
    s_nop 0
    buffer_load_dwordx4 v11, s[36:39], s55 offen  lds
    s_add_u32 s50, s50, 1
    s_cmp_eq_u32 s50, 10
    s_cselect_b32 s50, 0, s50
    s_waitcnt vmcnt(16)
    v_lshlrev_b32 v1, 2, v255
    v_add_u32 v1, s53, v1
    ds_read_b32 v24, v1 offset:0
    ds_read_b32 v25, v1 offset:160
    ds_read_b32 v26, v1 offset:320
    ds_read_b32 v27, v1 offset:480
    ds_read_b32 v28, v1 offset:640
    ds_read_b32 v29, v1 offset:800
    ds_read_b32 v30, v1 offset:960
    ds_read_b32 v31, v1 offset:1120
    ds_read_b32 v32, v1 offset:1280
    ds_read_b32 v33, v1 offset:1440
    ds_read_b32 v34, v1 offset:1600
    v_lshlrev_b32 v44, 16, v20
    v_lshlrev_b32 v45, 16, v22
    v_and_b32 v46, 0xffff0000, v20
    v_and_b32 v47, 0xffff0000, v22
    v_lshlrev_b32 v48, 16, v21
    v_lshlrev_b32 v49, 16, v23
    v_and_b32 v50, 0xffff0000, v21
    v_and_b32 v51, 0xffff0000, v23
    s_waitcnt lgkmcnt(0)
    ds_read_b32 v36, v1 offset:2048
    ds_read_b32 v37, v1 offset:2208
    ds_read_b32 v38, v1 offset:2368
    ds_read_b32 v39, v1 offset:2528
    ds_read_b32 v40, v1 offset:2688
    ds_read_b32 v41, v1 offset:2848
    ds_read_b32 v42, v1 offset:3008
    ds_read_b32 v43, v1 offset:3168
    v_lshlrev_b32 v52, 16, v24
    v_and_b32 v53, 0xffff0000, v24
    v_lshlrev_b32 v54, 16, v25
    v_and_b32 v55, 0xffff0000, v25
    v_lshlrev_b32 v56, 16, v26
    v_and_b32 v57, 0xffff0000, v26
    v_lshlrev_b32 v58, 16, v27
    v_and_b32 v59, 0xffff0000, v27
    v_lshlrev_b32 v60, 16, v28
    v_and_b32 v61, 0xffff0000, v28
    v_lshlrev_b32 v62, 16, v29
    v_and_b32 v63, 0xffff0000, v29
    v_lshlrev_b32 v64, 16, v30
    v_and_b32 v65, 0xffff0000, v30
    v_lshlrev_b32 v66, 16, v31
    v_and_b32 v67, 0xffff0000, v31
    v_lshlrev_b32 v68, 16, v32
    v_and_b32 v69, 0xffff0000, v32
    v_lshlrev_b32 v70, 16, v33
    v_and_b32 v71, 0xffff0000, v33
    v_lshlrev_b32 v72, 16, v34
    v_and_b32 v73, 0xffff0000, v34
    s_waitcnt lgkmcnt(0)
    v_lshlrev_b32 v74, 16, v36
    v_and_b32 v75, 0xffff0000, v36
    v_lshlrev_b32 v76, 16, v37
    v_and_b32 v77, 0xffff0000, v37
    v_lshlrev_b32 v78, 16, v38
    v_and_b32 v79, 0xffff0000, v38
    v_lshlrev_b32 v80, 16, v39
    v_and_b32 v81, 0xffff0000, v39
    v_lshlrev_b32 v82, 16, v40
    v_and_b32 v83, 0xffff0000, v40
    v_lshlrev_b32 v84, 16, v41
    v_and_b32 v85, 0xffff0000, v41
    v_lshlrev_b32 v86, 16, v42
    v_and_b32 v87, 0xffff0000, v42
    v_lshlrev_b32 v88, 16, v43
    v_and_b32 v89, 0xffff0000, v43
    v_pk_mul_f32 v[90:91], v[58:59], v[44:45]
    v_pk_fma_f32 v[90:91], v[56:57], v[46:47], v[90:91]
    v_pk_fma_f32 v[90:91], v[54:55], v[48:49], v[90:91]
    v_pk_fma_f32 v[90:91], v[52:53], v[50:51], v[90:91]
    v_pk_mul_f32 v[74:75], v[90:91], v[74:75]
    v_pk_mul_f32 v[92:93], v[60:61], v[44:45]
    v_pk_fma_f32 v[92:93], v[58:59], v[46:47], v[92:93]
    v_pk_fma_f32 v[92:93], v[56:57], v[48:49], v[92:93]
    v_pk_fma_f32 v[92:93], v[54:55], v[50:51], v[92:93]
    v_pk_mul_f32 v[76:77], v[92:93], v[76:77]
    v_pk_mul_f32 v[90:91], v[62:63], v[44:45]
    v_pk_fma_f32 v[90:91], v[60:61], v[46:47], v[90:91]
    v_pk_fma_f32 v[90:91], v[58:59], v[48:49], v[90:91]
    v_pk_fma_f32 v[90:91], v[56:57], v[50:51], v[90:91]
    v_pk_mul_f32 v[78:79], v[90:91], v[78:79]
    v_pk_mul_f32 v[92:93], v[64:65], v[44:45]
    v_pk_fma_f32 v[92:93], v[62:63], v[46:47], v[92:93]
    v_pk_fma_f32 v[92:93], v[60:61], v[48:49], v[92:93]
    v_pk_fma_f32 v[92:93], v[58:59], v[50:51], v[92:93]
    v_pk_mul_f32 v[80:81], v[92:93], v[80:81]
    v_pk_mul_f32 v[90:91], v[66:67], v[44:45]
    v_pk_fma_f32 v[90:91], v[64:65], v[46:47], v[90:91]
    v_pk_fma_f32 v[90:91], v[62:63], v[48:49], v[90:91]
    v_pk_fma_f32 v[90:91], v[60:61], v[50:51], v[90:91]
    v_pk_mul_f32 v[82:83], v[90:91], v[82:83]
    v_pk_mul_f32 v[92:93], v[68:69], v[44:45]
    v_pk_fma_f32 v[92:93], v[66:67], v[46:47], v[92:93]
    v_pk_fma_f32 v[92:93], v[64:65], v[48:49], v[92:93]
    v_pk_fma_f32 v[92:93], v[62:63], v[50:51], v[92:93]
    v_pk_mul_f32 v[84:85], v[92:93], v[84:85]
    v_pk_mul_f32 v[90:91], v[70:71], v[44:45]
    v_pk_fma_f32 v[90:91], v[68:69], v[46:47], v[90:91]
    v_pk_fma_f32 v[90:91], v[66:67], v[48:49], v[90:91]
    v_pk_fma_f32 v[90:91], v[64:65], v[50:51], v[90:91]
    v_pk_mul_f32 v[86:87], v[90:91], v[86:87]
    v_pk_mul_f32 v[92:93], v[72:73], v[44:45]
    v_pk_fma_f32 v[92:93], v[70:71], v[46:47], v[92:93]
    v_pk_fma_f32 v[92:93], v[68:69], v[48:49], v[92:93]
    v_pk_fma_f32 v[92:93], v[66:67], v[50:51], v[92:93]
    v_pk_mul_f32 v[88:89], v[92:93], v[88:89]
    v_cvt_pk_bf16_f32 v24, v88, v86
    v_cvt_pk_bf16_f32 v25, v84, v82
    v_cvt_pk_bf16_f32 v26, v80, v78
    v_cvt_pk_bf16_f32 v27, v76, v74
    v_cvt_pk_bf16_f32 v28, v89, v87
    v_cvt_pk_bf16_f32 v29, v85, v83
    v_cvt_pk_bf16_f32 v30, v81, v79
    v_cvt_pk_bf16_f32 v31, v77, v75
    v_and_b32 v2, 7, v255
    v_xor_b32 v2, s3, v2
    v_lshlrev_b32 v2, 4, v2
    v_lshl_add_u32 v2, v255, 8, v2
    v_add_u32 v3, 131072, v2
    s_mov_b32 exec_hi, 0xff
    ds_write_b128 v3, v[24:27]
    ds_write_b128 v3, v[28:31] offset:128
    s_mov_b64 exec, -1
    s_mul_i32 s54, s48, 163840
    s_lshl_b32 s51, s50, 7
    s_add_u32 s54, s54, s51
    s_mul_i32 s55, s50, 245760
    s_lshl_b32 s51, s49, 8
    s_add_u32 s55, s55, s51
    s_add_u32 m0, s59, 65536
    s_nop 0
    buffer_load_dwordx4 v4, s[32:35], s54 offen  lds
    s_add_u32 m0, s59, 81920
    s_nop 0
    buffer_load_dwordx4 v8, s[36:39], s55 offen  lds
    s_add_u32 m0, s59, 66560
    s_nop 0
    buffer_load_dwordx4 v5, s[32:35], s54 offen  lds
    s_add_u32 m0, s59, 82944
    s_nop 0
    buffer_load_dwordx4 v9, s[36:39], s55 offen  lds
    s_add_u32 m0, s59, 67584
    s_nop 0
    buffer_load_dwordx4 v6, s[32:35], s54 offen  lds
    s_add_u32 m0, s59, 83968
    s_nop 0
    buffer_load_dwordx4 v10, s[36:39], s55 offen  lds
    s_add_u32 m0, s59, 68608
    s_nop 0
    buffer_load_dwordx4 v7, s[32:35], s54 offen  lds
    s_add_u32 m0, s59, 84992
    s_nop 0
    buffer_load_dwordx4 v11, s[36:39], s55 offen  lds
    s_add_u32 s50, s50, 1
    s_cmp_eq_u32 s50, 10
    s_cselect_b32 s50, 0, s50
    s_waitcnt vmcnt(16) lgkmcnt(0)
    s_barrier
    s_and_b32 s52, s31, 3
    s_mul_i32 s53, s52, 5
    s_add_u32 s53, s53, 1
    s_lshr_b32 s53, s53, 1
    s_and_b32 s52, s52, 1
    s_and_b32 s99, s3, 3
    s_add_u32 s52, s52, s99
    s_cmp_ge_u32 s52, 3
    s_cselect_b32 s10, 1, 0
    s_add_u32 s53, s53, s99
    s_lshl_b32 s52, s30, 3
    s_lshr_b32 s96, s31, 2
    s_add_u32 s96, s96, s52
    s_mul_i32 s96, s96, 10
    s_add_u32 s96, s96, s53
    s_min_u32 s96, s96, 639
    s_mul_i32 s98, s99, 16640
    s_add_u32 s98, s98, 82432
    s_mul_i32 s99, s99, 4608
    s_add_u32 s99, s99, 132352
    s_lshl_b32 s52, s96, 1
    s_and_b32 s52, s52, 0xfffffffc
    s_load_dword s100, s[20:21], s52
    v_and_b32 v1, 15, v255
    v_lshrrev_b32 v2, 4, v255
    v_lshl_add_u32 v3, v1, 1, v2
    v_lshl_add_u32 v209, v3, 4, s99
    v_add_u32 v209, 32, v209
    v_lshl_add_u32 v3, v1, 2, v2
    v_lshlrev_b32 v234, 3, v3
    v_lshlrev_b32 v2, 3, v2
    v_sub_u32 v1, v1, v2
    v_add_u32 v2, 41, v1
    v_and_b32 v3, 1, v2
    v_mul_u32_u24 v3, 8328, v3
    v_lshrrev_b32 v2, 1, v2
    v_lshl_add_u32 v2, v2, 3, v3
    v_add_u32 v208, s98, v2
    v_lshl_add_u32 v12, v255, 3, s98
    v_lshl_add_u32 v13, v255, 2, s99
    v_add_u32 v13, 13824, v13
    v_sub_u32 v1, -9, v1
    v_and_b32 v2, 1, v1
    v_lshlrev_b32 v2, 4, v2
    v_lshrrev_b32 v1, 1, v1
    s_waitcnt lgkmcnt(0)
    s_lshr_b32 s52, s100, 16
    s_and_b32 s53, s100, 0xffff
    s_bitcmp1_b32 s96, 0
    s_cselect_b32 s52, s52, s53
    v_lshlrev_b32 v2, v2, s52
    v_cmp_eq_u32 s[94:95], 0, v1
    s_nop 1
    v_cndmask_b32 v228, 0, v2, s[94:95]
    v_cmp_eq_u32 s[94:95], 1, v1
    s_nop 1
    v_cndmask_b32 v229, 0, v2, s[94:95]
    v_cmp_eq_u32 s[94:95], 2, v1
    s_nop 1
    v_cndmask_b32 v230, 0, v2, s[94:95]
    v_cmp_eq_u32 s[94:95], 3, v1
    s_nop 1
    v_cndmask_b32 v231, 0, v2, s[94:95]
    v_and_b32 v1, 31, v255
    s_lshl_b32 s93, s30, 5
    v_add_u32 v1, s93, v1
    v_lshlrev_b32 v18, 5, v1
    s_waitcnt vmcnt(8)
    s_barrier
    s_mul_i32 s54, s48, 163840
    s_lshl_b32 s51, s50, 7
    s_add_u32 s54, s54, s51
    s_mul_i32 s55, s50, 245760
    s_lshl_b32 s51, s49, 8
    s_add_u32 s55, s55, s51
    s_add_u32 m0, s59, 0
    s_nop 0
    buffer_load_dwordx4 v4, s[32:35], s54 offen  lds
    s_add_u32 m0, s59, 16384
    s_nop 0
    buffer_load_dwordx4 v8, s[36:39], s55 offen  lds
    s_add_u32 m0, s59, 1024
    s_nop 0
    buffer_load_dwordx4 v5, s[32:35], s54 offen  lds
    s_add_u32 m0, s59, 17408
    s_nop 0
    buffer_load_dwordx4 v9, s[36:39], s55 offen  lds
    s_add_u32 m0, s59, 2048
    s_nop 0
    buffer_load_dwordx4 v6, s[32:35], s54 offen  lds
    s_add_u32 m0, s59, 18432
    s_nop 0
    buffer_load_dwordx4 v10, s[36:39], s55 offen  lds
    s_add_u32 m0, s59, 3072
    s_nop 0
    buffer_load_dwordx4 v7, s[32:35], s54 offen  lds
    s_add_u32 m0, s59, 19456
    s_nop 0
    buffer_load_dwordx4 v11, s[36:39], s55 offen  lds
    s_add_u32 s50, s50, 1
    s_cmp_eq_u32 s50, 10
    s_cselect_b32 s50, 0, s50
    s_lshl_b32 s80, s30, 2
    s_lshr_b32 s52, s31, 3
    s_add_u32 s80, s80, s52
    s_and_b32 s81, s31, 7
    s_lshr_b32 s82, s3, 2
    s_and_b32 s83, s3, 3
    s_lshl_b32 s84, s81, 3
    s_lshl_b32 s52, s83, 1
    s_add_u32 s84, s84, s52
    v_lshlrev_b32 v136, 4, v255
    s_lshl_b32 s86, s30, 2
    s_lshr_b32 s52, s31, 3
    s_add_u32 s86, s86, s52
    s_and_b32 s87, s31, 7
    s_mul_i32 s88, s82, 41216
    s_mul_i32 s52, s83, 2576
    s_add_u32 s88, s88, s52
    s_lshl_b32 s52, s87, 5
    v_and_b32 v1, 31, v255
    v_add_u32 v1, s52, v1
    v_lshlrev_b32 v1, 5, v1
    v_add_u32 v1, 16384, v1
    s_lshr_b32 s52, s86, 1
    s_lshl_b32 s52, s52, 5
    s_add_u32 s52, s52, 15872
    v_mov_b32 v2, s52
    v_cmp_gt_u32 s[94:95], 32, v255
    s_nop 1
    v_cndmask_b32 v237, v2, v1, s[94:95]
    v_and_b32 v1, 31, v255
    v_lshl_add_u32 v1, v1, 3, s30
    v_lshlrev_b32 v1, 5, v1
    v_add_u32 v236, 16384, v1
    s_cmp_eq_u32 s83, 0
    s_cselect_b32 s90, 1114112, 0
    s_mul_i32 s91, s82, 69888
    s_or_b32 s90, s90, s91
    s_mov_b32 s91, 0
    s_lshl_b32 s52, s83, 6
    v_add_u32 v1, s52, v255
    v_mul_u32_u24 v2, 104858, v1
    v_lshrrev_b32 v2, 20, v2
    v_mul_u32_u24 v3, 10, v2
    v_sub_u32 v3, v1, v3
    s_mul_i32 s53, s87, 160
    v_lshl_add_u32 v3, v3, 4, s53
    v_bfe_u32 v1, v2, 3, 1
    v_mul_u32_u24 v248, 20, v1
    v_bfe_u32 v1, v2, 2, 1
    v_lshl_add_u32 v248, v1, 3, v248
    v_lshrrev_b32 v1, 4, v2
    v_lshl_add_u32 v248, v1, 2, v248
    v_bfe_u32 v249, v2, 2, 2
    v_lshl_add_u32 v249, v1, 2, v249
    v_mul_u32_u24 v249, 20, v249
    v_and_b32 v1, 3, v2
    v_add_u32 v248, v248, v1
    v_add3_u32 v249, v249, v1, 16
    v_mul_u32_u24 v248, 1280, v248
    v_mul_u32_u24 v249, 1280, v249
    v_add_u32 v248, v248, v3
    v_add_u32 v249, v249, v3
    s_waitcnt vmcnt(8)
    s_barrier
    s_mul_i32 s54, s48, 163840
    s_lshl_b32 s51, s50, 7
    s_add_u32 s54, s54, s51
    s_mul_i32 s55, s50, 245760
    s_lshl_b32 s51, s49, 8
    s_add_u32 s55, s55, s51
    s_add_u32 m0, s59, 32768
    s_nop 0
    buffer_load_dwordx4 v4, s[32:35], s54 offen  lds
    s_add_u32 m0, s59, 49152
    s_nop 0
    buffer_load_dwordx4 v8, s[36:39], s55 offen  lds
    s_add_u32 m0, s59, 33792
    s_nop 0
    buffer_load_dwordx4 v5, s[32:35], s54 offen  lds
    s_add_u32 m0, s59, 50176
    s_nop 0
    buffer_load_dwordx4 v9, s[36:39], s55 offen  lds
    s_add_u32 m0, s59, 34816
    s_nop 0
    buffer_load_dwordx4 v6, s[32:35], s54 offen  lds
    s_add_u32 m0, s59, 51200
    s_nop 0
    buffer_load_dwordx4 v10, s[36:39], s55 offen  lds
    s_add_u32 m0, s59, 35840
    s_nop 0
    buffer_load_dwordx4 v7, s[32:35], s54 offen  lds
    s_add_u32 m0, s59, 52224
    s_nop 0
    buffer_load_dwordx4 v11, s[36:39], s55 offen  lds
    s_add_u32 s50, s50, 1
    s_cmp_eq_u32 s50, 10
    s_cselect_b32 s50, 0, s50
    s_mul_i32 s58, s82, 41216
    s_mul_i32 s62, s83, 2576
    s_add_u32 s62, s62, s58
    s_mul_i32 s60, s83, 2560
    v_and_b32 v1, 31, v255
    v_lshrrev_b32 v2, 5, v255
    v_lshl_add_u32 v125, v1, 3, s58
    v_lshl_add_u32 v124, v2, 9, v125
    v_and_b32 v1, 3, v255
    v_lshlrev_b32 v3, 1, v1
    v_lshrrev_b32 v144, 1, v1
    v_or_b32 v3, v3, v144
    v_and_b32 v3, 3, v3
    v_and_b32 v144, 16, v255
    v_cmp_eq_u32 s[52:53], 0, v144
    s_nop 1
    v_cndmask_b32 v3, 4, v3, s[52:53]
    v_bfe_u32 v144, v255, 2, 2
    v_lshl_add_u32 v144, v2, 2, v144
    v_lshlrev_b32 v145, 2, v3
    v_lshlrev_b32 v3, 8, v3
    v_add3_u32 v3, v3, s58, 0
    v_add_u32 v3, 1280, v3
    v_and_b32 v146, 19, v255
    v_cmp_lt_u32 s[52:53], 16, v146
    v_cmp_eq_u32 vcc, 1, v1
    v_mov_b32 v146, 2560
    v_mov_b32 v147, 2568
    v_cndmask_b32_e64 v146, v146, v147, vcc
    v_add_u32 v146, s58, v146
    v_add_u32 v147, 0, v144
    v_xor_b32 v147, v147, v145
    v_lshl_add_u32 v147, v147, 3, v3
    v_cndmask_b32 v126, v147, v146, s[52:53]
    v_add_u32 v147, 8, v144
    v_xor_b32 v147, v147, v145
    v_lshl_add_u32 v147, v147, 3, v3
    v_cndmask_b32 v127, v147, v146, s[52:53]
    v_add_u32 v147, 16, v144
    v_xor_b32 v147, v147, v145
    v_lshl_add_u32 v147, v147, 3, v3
    v_cndmask_b32 v128, v147, v146, s[52:53]
    v_add_u32 v147, 24, v144
    v_xor_b32 v147, v147, v145
    v_lshl_add_u32 v147, v147, 3, v3
    v_cndmask_b32 v129, v147, v146, s[52:53]
    s_lshl_b32 s52, s82, 2
    s_add_u32 s53, s52, 163776
    v_mov_b32 v137, s53
    s_sub_u32 s53, 163780, s52
    v_mov_b32 v131, s53
    v_mov_b32 v138, 1
    s_mov_b32 s63, 0
    s_mov_b32 s61, 0
    v_bfe_u32 v1, v255, 4, 1
    v_mul_u32_u24 v1, 20480, v1
    v_and_b32 v3, 15, v255
    v_bfe_u32 v2, v255, 1, 1
    v_xor_b32 v3, v3, v2
    v_lshrrev_b32 v2, 5, v255
    v_lshl_add_u32 v2, v2, 4, v3
    v_lshl_add_u32 v232, v2, 4, v1
    v_lshl_add_u32 v233, v3, 3, v1
    v_subrev_u32 v132, s58, v124
    v_lshrrev_b32 v2, 5, v255
    v_mul_u32_u24 v2, 768, v2
    v_add_u32 v133, v132, v2
    s_waitcnt vmcnt(8)
    s_barrier
    s_mul_i32 s54, s48, 163840
    s_lshl_b32 s51, s50, 7
    s_add_u32 s54, s54, s51
    s_mul_i32 s55, s50, 245760
    s_lshl_b32 s51, s49, 8
    s_add_u32 s55, s55, s51
    s_add_u32 m0, s59, 65536
    s_nop 0
    buffer_load_dwordx4 v4, s[32:35], s54 offen  lds
    s_add_u32 m0, s59, 81920
    s_nop 0
    buffer_load_dwordx4 v8, s[36:39], s55 offen  lds
    s_add_u32 m0, s59, 66560
    s_nop 0
    buffer_load_dwordx4 v5, s[32:35], s54 offen  lds
    s_add_u32 m0, s59, 82944
    s_nop 0
    buffer_load_dwordx4 v9, s[36:39], s55 offen  lds
    s_add_u32 m0, s59, 67584
    s_nop 0
    buffer_load_dwordx4 v6, s[32:35], s54 offen  lds
    s_add_u32 m0, s59, 83968
    s_nop 0
    buffer_load_dwordx4 v10, s[36:39], s55 offen  lds
    s_add_u32 m0, s59, 68608
    s_nop 0
    buffer_load_dwordx4 v7, s[32:35], s54 offen  lds
    s_add_u32 m0, s59, 84992
    s_nop 0
    buffer_load_dwordx4 v11, s[36:39], s55 offen  lds
    s_add_u32 s50, s50, 1
    s_cmp_eq_u32 s50, 10
    s_cselect_b32 s50, 0, s50
    v_add_u32 v1, 256, v255
    v_mul_u32_u24 v2, 104858, v1
    v_lshrrev_b32 v2, 20, v2
    v_mul_u32_u24 v3, 10, v2
    v_sub_u32 v3, v1, v3
    s_mul_i32 s53, s87, 160
    v_lshl_add_u32 v3, v3, 4, s53
    v_bfe_u32 v1, v2, 3, 1
    v_mul_u32_u24 v246, 20, v1
    v_bfe_u32 v1, v2, 2, 1
    v_lshl_add_u32 v246, v1, 3, v246
    v_lshrrev_b32 v1, 4, v2
    v_lshl_add_u32 v246, v1, 2, v246
    v_bfe_u32 v247, v2, 2, 2
    v_lshl_add_u32 v247, v1, 2, v247
    v_mul_u32_u24 v247, 20, v247
    v_and_b32 v1, 3, v2
    v_add_u32 v246, v246, v1
    v_add3_u32 v247, v247, v1, 16
    v_mul_u32_u24 v246, 1280, v246
    v_mul_u32_u24 v247, 1280, v247
    v_add_u32 v246, v246, v3
    v_add_u32 v247, v247, v3
    s_mul_i32 s52, s87, 327680
    s_lshl_b32 s53, s86, 7
    s_add_u32 s52, s52, s53
    s_lshl_b32 s53, s83, 5
    s_add_u32 s52, s52, s53
    v_lshrrev_b32 v1, 1, v255
    v_lshl_add_u32 v1, v1, 12, s52
    v_and_b32 v2, 1, v255
    v_lshl_add_u32 v250, v2, 4, v1
    v_add_u32 v251, 131072, v250
    v_add_u32 v252, 196608, v250
    s_lshl_b32 s52, s86, 2
    s_add_u32 s52, s52, s83
    s_lshl_b32 s52, s52, 4
    v_and_b32 v1, 15, v255
    v_add_u32 v1, s52, v1
    v_lshlrev_b32 v254, 2, v1
    v_mul_u32_u24 v1, 1280, v1
    v_lshrrev_b32 v2, 4, v255
    v_lshl_add_u32 v1, v2, 3, v1
    s_mul_i32 s52, s87, 160
    s_mul_i32 s53, s82, 64
    s_add_u32 s52, s52, s53
    v_add_u32 v253, s52, v1
    s_waitcnt vmcnt(8)
    s_barrier
    s_mul_i32 s54, s48, 163840
    s_lshl_b32 s51, s50, 7
    s_add_u32 s54, s54, s51
    s_mul_i32 s55, s50, 245760
    s_lshl_b32 s51, s49, 8
    s_add_u32 s55, s55, s51
    s_add_u32 m0, s59, 0
    s_nop 0
    buffer_load_dwordx4 v4, s[32:35], s54 offen  lds
    s_add_u32 m0, s59, 16384
    s_nop 0
    buffer_load_dwordx4 v8, s[36:39], s55 offen  lds
    s_add_u32 m0, s59, 1024
    s_nop 0
    buffer_load_dwordx4 v5, s[32:35], s54 offen  lds
    s_add_u32 m0, s59, 17408
    s_nop 0
    buffer_load_dwordx4 v9, s[36:39], s55 offen  lds
    s_add_u32 m0, s59, 2048
    s_nop 0
    buffer_load_dwordx4 v6, s[32:35], s54 offen  lds
    s_add_u32 m0, s59, 18432
    s_nop 0
    buffer_load_dwordx4 v10, s[36:39], s55 offen  lds
    s_add_u32 m0, s59, 3072
    s_nop 0
    buffer_load_dwordx4 v7, s[32:35], s54 offen  lds
    s_add_u32 m0, s59, 19456
    s_nop 0
    buffer_load_dwordx4 v11, s[36:39], s55 offen  lds
    s_add_u32 s50, s50, 1
    s_cmp_eq_u32 s50, 10
    s_cselect_b32 s50, 0, s50
    s_mov_b32 s40, s18
    s_mov_b32 s41, s19
    s_mov_b32 s42, 2621440
    s_mov_b32 s43, 0x00020000
    s_cmp_eq_u32 s10, 0
    s_cbranch_scc0 CVI_17
    v_lshlrev_b32 v1, 4, v255
    v_subrev_u32 v14, 64, v1
    v_add_u32 v15, 960, v1
    s_lshl_b32 s52, s96, 12
    s_add_u32 m0, s99, 13824
    s_nop 0
    buffer_load_dwordx4 v14, s[40:43], s52 offen nt lds
    s_add_u32 m0, s99, 14848
    s_nop 0
    buffer_load_dwordx4 v15, s[40:43], s52 offen offset:0 nt lds
    buffer_load_dwordx4 v15, s[40:43], s52 offen offset:1024 nt lds
    buffer_load_dwordx4 v15, s[40:43], s52 offen offset:2048 nt lds
    s_mov_b64 exec, 0x1ff
    buffer_load_dwordx4 v15, s[40:43], s52 offen offset:3072 nt lds
    s_mov_b64 exec, -1
    s_branch CVE_18
CVI_17:
    v_mov_b32 v1, -1
    buffer_load_dword v16, v1, s[40:43], 0 offen
    buffer_load_dword v16, v1, s[40:43], 0 offen
    buffer_load_dword v16, v1, s[40:43], 0 offen
    buffer_load_dword v16, v1, s[40:43], 0 offen
    buffer_load_dword v16, v1, s[40:43], 0 offen
CVE_18:
    s_lshl_b32 s52, s82, 13
    v_add_u32 v216, s52, v136
    v_add_u32 v218, 4096, v216
    v_lshlrev_b32 v1, 3, v255
    v_and_b32 v2, 15, v255
    s_lshl_b32 s52, s82, 11
    s_add_u32 s52, s52, 16384
    v_add_u32 v217, s52, v1
    v_lshrrev_b32 v1, 2, v255
    v_mul_u32_u24 v1, 160, v1
    v_and_b32 v2, 3, v255
    v_lshl_add_u32 v1, v2, 3, v1
    s_mul_i32 s52, s82, 35840
    s_add_u32 s52, s52, 82432
    v_add_u32 v210, s52, v1
    s_mul_i32 s52, s82, 15360
    s_add_u32 s52, s52, 10304
    v_add_u32 v211, s52, v1
    s_lshl_b32 s52, s82, 10
    s_add_u32 s52, s52, s88
    v_lshl_add_u32 v212, v255, 3, s52
    s_mul_i32 s52, s83, 5120
    s_add_u32 s52, s52, 61760
    v_add_u32 v213, s52, v136
    v_and_b32 v2, 15, v255
    s_mov_b32 s57, 41216
    s_mul_i32 s52, s3, 5376
    s_add_u32 s52, s52, 41216
    s_cmp_eq_u32 s3, 7
    s_cselect_b32 s52, 0, s52
    v_and_b32 v1, 15, v255
    v_mul_u32_u24 v1, 336, v1
    v_lshrrev_b32 v2, 4, v255
    v_lshl_add_u32 v1, v2, 4, v1
    v_add_u32 v215, s52, v1
    s_lshl_b32 s53, s3, 6
    v_add_u32 v1, s53, v255
    v_mul_u32_u24 v2, 104858, v1
    v_lshrrev_b32 v2, 20, v2
    v_mul_u32_u24 v3, 10, v2
    v_sub_u32 v3, v1, v3
    v_mul_u32_u24 v1, 1280, v2
    v_lshl_add_u32 v220, v3, 4, v1
    v_and_b32 v1, 15, v2
    v_mul_u32_u24 v1, 336, v1
    v_lshl_add_u32 v1, v3, 5, v1
    v_lshrrev_b32 v2, 4, v2
    v_mul_u32_u24 v3, 5376, v2
    v_add3_u32 v221, v1, v3, s57
    v_add_u32 v3, 21504, v221
    v_cmp_eq_u32 s[94:95], 3, v2
    s_nop 1
    v_cndmask_b32 v222, v3, v1, s[94:95]
    v_add_u32 v1, s53, v255
    v_add_u32 v1, 512, v1
    v_mul_u32_u24 v2, 104858, v1
    v_lshrrev_b32 v2, 20, v2
    v_mul_u32_u24 v3, 10, v2
    v_sub_u32 v3, v1, v3
    v_mul_u32_u24 v1, 1280, v2
    v_lshl_add_u32 v223, v3, 4, v1
    v_and_b32 v1, 15, v2
    v_mul_u32_u24 v1, 336, v1
    v_lshl_add_u32 v1, v3, 5, v1
    v_lshrrev_b32 v2, 4, v2
    v_mul_u32_u24 v3, 5376, v2
    v_add3_u32 v224, v1, v3, s57
    v_add_u32 v3, 21504, v224
    v_cmp_eq_u32 s[94:95], 3, v2
    s_nop 1
    v_cndmask_b32 v225, v3, v1, s[94:95]
    s_waitcnt vmcnt(13)
    s_barrier
    s_mul_i32 s54, s48, 163840
    s_lshl_b32 s51, s50, 7
    s_add_u32 s54, s54, s51
    s_mul_i32 s55, s50, 245760
    s_lshl_b32 s51, s49, 8
    s_add_u32 s55, s55, s51
    s_add_u32 m0, s59, 32768
    s_nop 0
    buffer_load_dwordx4 v4, s[32:35], s54 offen  lds
    s_add_u32 m0, s59, 49152
    s_nop 0
    buffer_load_dwordx4 v8, s[36:39], s55 offen  lds
    s_add_u32 m0, s59, 33792
    s_nop 0
    buffer_load_dwordx4 v5, s[32:35], s54 offen  lds
    s_add_u32 m0, s59, 50176
    s_nop 0
    buffer_load_dwordx4 v9, s[36:39], s55 offen  lds
    s_add_u32 m0, s59, 34816
    s_nop 0
    buffer_load_dwordx4 v6, s[32:35], s54 offen  lds
    s_add_u32 m0, s59, 51200
    s_nop 0
    buffer_load_dwordx4 v10, s[36:39], s55 offen  lds
    s_add_u32 m0, s59, 35840
    s_nop 0
    buffer_load_dwordx4 v7, s[32:35], s54 offen  lds
    s_add_u32 m0, s59, 52224
    s_nop 0
    buffer_load_dwordx4 v11, s[36:39], s55 offen  lds
    s_add_u32 s50, s50, 1
    s_cmp_eq_u32 s50, 10
    s_cselect_b32 s50, 0, s50
    s_waitcnt vmcnt(13)
    s_barrier
    s_cmp_eq_u32 s3, 4
    s_cbranch_scc0 F_NOQ
    s_add_u32 s44, s28, 15794176
    s_addc_u32 s45, s29, 0
    s_mov_b32 s46, 24576
    s_mov_b32 s47, 0x00020000
    buffer_load_dword v19, v18, s[44:47], 0 offen sc1
F_NOQ:
    s_mul_i32 s54, s48, 163840
    s_lshl_b32 s51, s50, 7
    s_add_u32 s54, s54, s51
    s_mul_i32 s55, s50, 245760
    s_lshl_b32 s51, s49, 8
    s_add_u32 s55, s55, s51
    s_add_u32 m0, s59, 65536
    s_nop 0
    buffer_load_dwordx4 v4, s[32:35], s54 offen  lds
    s_add_u32 m0, s59, 81920
    s_nop 0
    buffer_load_dwordx4 v8, s[36:39], s55 offen  lds
    s_add_u32 m0, s59, 66560
    s_nop 0
    buffer_load_dwordx4 v5, s[32:35], s54 offen  lds
    s_add_u32 m0, s59, 82944
    s_nop 0
    buffer_load_dwordx4 v9, s[36:39], s55 offen  lds
    s_add_u32 m0, s59, 67584
    s_nop 0
    buffer_load_dwordx4 v6, s[32:35], s54 offen  lds
    s_add_u32 m0, s59, 83968
    s_nop 0
    buffer_load_dwordx4 v10, s[36:39], s55 offen  lds
    s_add_u32 m0, s59, 68608
    s_nop 0
    buffer_load_dwordx4 v7, s[32:35], s54 offen  lds
    s_add_u32 m0, s59, 84992
    s_nop 0
    buffer_load_dwordx4 v11, s[36:39], s55 offen  lds
    s_add_u32 s50, s50, 1
    s_cmp_eq_u32 s50, 10
    s_cselect_b32 s50, 0, s50
    s_waitcnt vmcnt(8)
    s_barrier
    s_mul_i32 s54, s48, 163840
    s_lshl_b32 s51, s50, 7
    s_add_u32 s54, s54, s51
    s_mul_i32 s55, s50, 245760
    s_lshl_b32 s51, s49, 8
    s_add_u32 s55, s55, s51
    s_add_u32 m0, s59, 0
    s_nop 0
    buffer_load_dwordx4 v4, s[32:35], s54 offen  lds
    s_add_u32 m0, s59, 16384
    s_nop 0
    buffer_load_dwordx4 v8, s[36:39], s55 offen  lds
    s_add_u32 m0, s59, 1024
    s_nop 0
    buffer_load_dwordx4 v5, s[32:35], s54 offen  lds
    s_add_u32 m0, s59, 17408
    s_nop 0
    buffer_load_dwordx4 v9, s[36:39], s55 offen  lds
    s_add_u32 m0, s59, 2048
    s_nop 0
    buffer_load_dwordx4 v6, s[32:35], s54 offen  lds
    s_add_u32 m0, s59, 18432
    s_nop 0
    buffer_load_dwordx4 v10, s[36:39], s55 offen  lds
    s_add_u32 m0, s59, 3072
    s_nop 0
    buffer_load_dwordx4 v7, s[32:35], s54 offen  lds
    s_add_u32 m0, s59, 19456
    s_nop 0
    buffer_load_dwordx4 v11, s[36:39], s55 offen  lds
    s_add_u32 s50, s50, 1
    s_cmp_eq_u32 s50, 10
    s_cselect_b32 s50, 0, s50
    s_waitcnt vmcnt(8)
    s_cmp_eq_u32 s3, 4
    s_cbranch_scc0 F_F1OK
    s_waitcnt vmcnt(16)
    v_cmp_ne_u32 s[94:95], 1, v19
    s_nop 0
    s_cmp_eq_u64 s[94:95], 0
    s_cbranch_scc1 F_F1OK
    s_add_u32 s44, s28, 15794176
    s_addc_u32 s45, s29, 0
    s_mov_b32 s46, 24576
    s_mov_b32 s47, 0x00020000
    s_mov_b32 s89, 400000
SP_19:
    buffer_load_dword v19, v18, s[44:47], 0 offen sc1
    s_waitcnt vmcnt(0)
    v_cmp_ne_u32 s[94:95], 1, v19
    s_nop 0
    s_cmp_eq_u64 s[94:95], 0
    s_cbranch_scc1 SE_20
    s_sub_u32 s89, s89, 1
    s_cbranch_scc0 SP_19
SE_20:
F_F1OK:
    s_barrier
    s_add_u32 s40, s28, 7864320
    s_addc_u32 s41, s29, 0
    s_mov_b32 s42, 2621440
    s_mov_b32 s43, 0x00020000
    s_cmp_eq_u32 s10, 0
    s_cbranch_scc0 CVI_21
    v_lshlrev_b32 v1, 4, v255
    s_lshl_b32 s52, s96, 12
    s_add_u32 m0, s99, 512
    v_mov_b32 v2, 0
    v_mov_b32 v3, 0
    buffer_load_dwordx4 v1, s[40:43], s52 offen offset:0 sc1 lds
    buffer_load_dwordx4 v1, s[40:43], s52 offen offset:1024 sc1 lds
    buffer_load_dwordx4 v1, s[40:43], s52 offen offset:2048 sc1 lds
    buffer_load_dwordx4 v1, s[40:43], s52 offen offset:3072 sc1 lds
    v_lshl_add_u32 v1, v255, 3, s99
    ds_write_b64 v1, v[2:3]
    s_branch CVE_22
CVI_21:
    v_mov_b32 v1, -1
    buffer_load_dword v16, v1, s[40:43], 0 offen
    buffer_load_dword v16, v1, s[40:43], 0 offen
    buffer_load_dword v16, v1, s[40:43], 0 offen
    buffer_load_dword v16, v1, s[40:43], 0 offen
CVE_22:
    s_mul_i32 s52, s80, 163840
    s_mul_i32 s53, s82, 81920
    s_add_u32 s52, s52, s53
    s_add_u32 s52, s52, 2621440
    s_add_u32 s32, s28, s52
    s_addc_u32 s33, s29, 0
    s_mov_b32 s34, 81920
    s_mov_b32 s35, 0x00020000
    s_add_u32 s36, s28, 13107200
    s_addc_u32 s37, s29, 0
    s_mov_b32 s38, 2621440
    s_mov_b32 s39, 0x00020000
    s_add_u32 s52, s84, s82
    s_mul_i32 s52, s52, 40960
    s_lshl_b32 s48, s80, 9
    s_add_u32 s48, s48, s52
    s_lshl_b32 s49, s80, 7
    s_add_u32 s49, s49, s52
    s_add_u32 s49, s49, 16384
    s_mov_b32 s50, 0
    s_waitcnt vmcnt(4)
    s_barrier
    s_cmp_eq_u32 s10, 0
    s_cbranch_scc0 CVI_23
    ds_read_b32 v36, v13 offset:0
    ds_read_b32 v37, v13 offset:4
    ds_read_b32 v38, v13 offset:8
    ds_read_b32 v42, v13 offset:256
    ds_read_b32 v43, v13 offset:260
    ds_read_b32 v44, v13 offset:264
    ds_read_b32 v48, v13 offset:512
    ds_read_b32 v49, v13 offset:516
    ds_read_b32 v50, v13 offset:520
    s_waitcnt lgkmcnt(0)
    ds_read_b32 v54, v13 offset:768
    ds_read_b32 v55, v13 offset:772
    ds_read_b32 v56, v13 offset:776
    ds_read_b32 v60, v13 offset:1024
    ds_read_b32 v61, v13 offset:1028
    ds_read_b32 v62, v13 offset:1032
    ds_read_b32 v66, v13 offset:1280
    ds_read_b32 v67, v13 offset:1284
    ds_read_b32 v68, v13 offset:1288
    v_alignbit_b32 v40, v37, v36, 16
    v_alignbit_b32 v41, v38, v37, 16
    ds_write_b64 v12, v[36:37] offset:0
    ds_write_b64 v12, v[40:41] offset:8328
    v_alignbit_b32 v46, v43, v42, 16
    v_alignbit_b32 v47, v44, v43, 16
    ds_write_b64 v12, v[42:43] offset:512
    ds_write_b64 v12, v[46:47] offset:8840
    v_alignbit_b32 v52, v49, v48, 16
    v_alignbit_b32 v53, v50, v49, 16
    ds_write_b64 v12, v[48:49] offset:1024
    ds_write_b64 v12, v[52:53] offset:9352
    s_waitcnt lgkmcnt(6)
    ds_read_b32 v36, v13 offset:1536
    ds_read_b32 v37, v13 offset:1540
    ds_read_b32 v38, v13 offset:1544
    ds_read_b32 v42, v13 offset:1792
    ds_read_b32 v43, v13 offset:1796
    ds_read_b32 v44, v13 offset:1800
    ds_read_b32 v48, v13 offset:2048
    ds_read_b32 v49, v13 offset:2052
    ds_read_b32 v50, v13 offset:2056
    v_alignbit_b32 v58, v55, v54, 16
    v_alignbit_b32 v59, v56, v55, 16
    ds_write_b64 v12, v[54:55] offset:1536
    ds_write_b64 v12, v[58:59] offset:9864
    v_alignbit_b32 v64, v61, v60, 16
    v_alignbit_b32 v65, v62, v61, 16
    ds_write_b64 v12, v[60:61] offset:2048
    ds_write_b64 v12, v[64:65] offset:10376
    v_alignbit_b32 v70, v67, v66, 16
    v_alignbit_b32 v71, v68, v67, 16
    ds_write_b64 v12, v[66:67] offset:2560
    ds_write_b64 v12, v[70:71] offset:10888
    s_waitcnt lgkmcnt(6)
    ds_read_b32 v54, v13 offset:2304
    ds_read_b32 v55, v13 offset:2308
    ds_read_b32 v56, v13 offset:2312
    ds_read_b32 v60, v13 offset:2560
    ds_read_b32 v61, v13 offset:2564
    ds_read_b32 v62, v13 offset:2568
    ds_read_b32 v66, v13 offset:2816
    ds_read_b32 v67, v13 offset:2820
    ds_read_b32 v68, v13 offset:2824
    v_alignbit_b32 v40, v37, v36, 16
    v_alignbit_b32 v41, v38, v37, 16
    ds_write_b64 v12, v[36:37] offset:3072
    ds_write_b64 v12, v[40:41] offset:11400
    v_alignbit_b32 v46, v43, v42, 16
    v_alignbit_b32 v47, v44, v43, 16
    ds_write_b64 v12, v[42:43] offset:3584
    ds_write_b64 v12, v[46:47] offset:11912
    v_alignbit_b32 v52, v49, v48, 16
    v_alignbit_b32 v53, v50, v49, 16
    ds_write_b64 v12, v[48:49] offset:4096
    ds_write_b64 v12, v[52:53] offset:12424
    s_waitcnt lgkmcnt(6)
    ds_read_b32 v36, v13 offset:3072
    ds_read_b32 v37, v13 offset:3076
    ds_read_b32 v38, v13 offset:3080
    ds_read_b32 v42, v13 offset:3328
    ds_read_b32 v43, v13 offset:3332
    ds_read_b32 v44, v13 offset:3336
    ds_read_b32 v48, v13 offset:3584
    ds_read_b32 v49, v13 offset:3588
    ds_read_b32 v50, v13 offset:3592
    v_alignbit_b32 v58, v55, v54, 16
    v_alignbit_b32 v59, v56, v55, 16
    ds_write_b64 v12, v[54:55] offset:4608
    ds_write_b64 v12, v[58:59] offset:12936
    v_alignbit_b32 v64, v61, v60, 16
    v_alignbit_b32 v65, v62, v61, 16
    ds_write_b64 v12, v[60:61] offset:5120
    ds_write_b64 v12, v[64:65] offset:13448
    v_alignbit_b32 v70, v67, v66, 16
    v_alignbit_b32 v71, v68, v67, 16
    ds_write_b64 v12, v[66:67] offset:5632
    ds_write_b64 v12, v[70:71] offset:13960
    s_waitcnt lgkmcnt(6)
    ds_read_b32 v54, v13 offset:3840
    ds_read_b32 v55, v13 offset:3844
    ds_read_b32 v56, v13 offset:3848
    ds_read_b32 v60, v13 offset:4096
    ds_read_b32 v61, v13 offset:4100
    ds_read_b32 v62, v13 offset:4104
    v_alignbit_b32 v40, v37, v36, 16
    v_alignbit_b32 v41, v38, v37, 16
    ds_write_b64 v12, v[36:37] offset:6144
    ds_write_b64 v12, v[40:41] offset:14472
    v_alignbit_b32 v46, v43, v42, 16
    v_alignbit_b32 v47, v44, v43, 16
    ds_write_b64 v12, v[42:43] offset:6656
    ds_write_b64 v12, v[46:47] offset:14984
    v_alignbit_b32 v52, v49, v48, 16
    v_alignbit_b32 v53, v50, v49, 16
    ds_write_b64 v12, v[48:49] offset:7168
    ds_write_b64 v12, v[52:53] offset:15496
    s_waitcnt lgkmcnt(6)
    v_alignbit_b32 v58, v55, v54, 16
    v_alignbit_b32 v59, v56, v55, 16
    ds_write_b64 v12, v[54:55] offset:7680
    ds_write_b64 v12, v[58:59] offset:16008
    v_alignbit_b32 v64, v61, v60, 16
    v_alignbit_b32 v65, v62, v61, 16
    s_mov_b64 exec, 0x7fff
    ds_write_b64 v12, v[60:61] offset:8192
    ds_write_b64 v12, v[64:65] offset:16520
    s_mov_b64 exec, -1
    s_branch CVE_24
CVI_23:
CVE_24:
    s_cmp_eq_u32 s10, 1
    s_cbranch_scc1 F_NOCONV
    s_waitcnt vmcnt(0) lgkmcnt(0)
    ds_read_b128 v[68:71], v209 offset:448
    ds_read_b64 v[36:37], v208 offset:0
    ds_read_b64 v[38:39], v208 offset:16
    ds_read_b128 v[72:75], v209 offset:960
    ds_read_b64 v[40:41], v208 offset:1024
    ds_read_b64 v[42:43], v208 offset:1040
    ds_read_b128 v[76:79], v209 offset:1472
    ds_read_b64 v[44:45], v208 offset:2048
    ds_read_b64 v[46:47], v208 offset:2064
    ds_read_b128 v[80:83], v209 offset:1984
    ds_read_b64 v[48:49], v208 offset:3072
    ds_read_b64 v[50:51], v208 offset:3088
    ds_read_b128 v[84:87], v209 offset:2496
    ds_read_b64 v[52:53], v208 offset:4096
    ds_read_b64 v[54:55], v208 offset:4112
    ds_read_b128 v[88:91], v209 offset:3008
    ds_read_b64 v[56:57], v208 offset:5120
    ds_read_b64 v[58:59], v208 offset:5136
    ds_read_b128 v[92:95], v209 offset:3520
    ds_read_b64 v[60:61], v208 offset:6144
    ds_read_b64 v[62:63], v208 offset:6160
    ds_read_b128 v[96:99], v209 offset:4032
    ds_read_b64 v[64:65], v208 offset:7168
    ds_read_b64 v[66:67], v208 offset:7184
    s_add_u32 s40, s28, 10485760
    s_addc_u32 s41, s29, 0
    s_mov_b32 s42, 2621440
    s_mov_b32 s43, 0x00020000
    s_lshl_b32 s52, s96, 12
    s_waitcnt lgkmcnt(0)
    v_mfma_f32_16x16x32_bf16 v[4:7], v[228:231], v[68:71], 0
    v_mfma_f32_16x16x32_bf16 v[8:11], v[228:231], v[72:75], 0
    v_mfma_f32_16x16x32_bf16 v[12:15], v[228:231], v[76:79], 0
    v_mfma_f32_16x16x32_bf16 v[16:19], v[228:231], v[80:83], 0
    v_mfma_f32_16x16x32_bf16 v[20:23], v[228:231], v[84:87], 0
    v_mfma_f32_16x16x32_bf16 v[24:27], v[228:231], v[88:91], 0
    v_mfma_f32_16x16x32_bf16 v[28:31], v[228:231], v[92:95], 0
    v_mfma_f32_16x16x32_bf16 v[32:35], v[228:231], v[96:99], 0
    v_mfma_f32_16x16x32_bf16 v[4:7], v[36:39], v[68:71], v[4:7]
    ds_read_b128 v[164:167], v209 offset:384
    v_mfma_f32_16x16x32_bf16 v[8:11], v[36:39], v[72:75], v[8:11]
    ds_read_b64 v[100:101], v208 offset:128
    v_mfma_f32_16x16x32_bf16 v[12:15], v[36:39], v[76:79], v[12:15]
    ds_read_b64 v[102:103], v208 offset:144
    v_mfma_f32_16x16x32_bf16 v[16:19], v[36:39], v[80:83], v[16:19]
    ds_read_b128 v[168:171], v209 offset:896
    v_mfma_f32_16x16x32_bf16 v[20:23], v[36:39], v[84:87], v[20:23]
    ds_read_b64 v[104:105], v208 offset:1152
    v_mfma_f32_16x16x32_bf16 v[24:27], v[36:39], v[88:91], v[24:27]
    ds_read_b64 v[106:107], v208 offset:1168
    v_mfma_f32_16x16x32_bf16 v[28:31], v[36:39], v[92:95], v[28:31]
    ds_read_b128 v[172:175], v209 offset:1408
    v_mfma_f32_16x16x32_bf16 v[32:35], v[36:39], v[96:99], v[32:35]
    ds_read_b64 v[108:109], v208 offset:2176
    v_mfma_f32_16x16x32_bf16 v[8:11], v[40:43], v[68:71], v[8:11]
    ds_read_b64 v[110:111], v208 offset:2192
    v_mfma_f32_16x16x32_bf16 v[12:15], v[40:43], v[72:75], v[12:15]
    ds_read_b128 v[176:179], v209 offset:1920
    v_mfma_f32_16x16x32_bf16 v[16:19], v[40:43], v[76:79], v[16:19]
    ds_read_b64 v[112:113], v208 offset:3200
    v_mfma_f32_16x16x32_bf16 v[20:23], v[40:43], v[80:83], v[20:23]
    ds_read_b64 v[114:115], v208 offset:3216
    v_mfma_f32_16x16x32_bf16 v[24:27], v[40:43], v[84:87], v[24:27]
    ds_read_b128 v[180:183], v209 offset:2432
    v_mfma_f32_16x16x32_bf16 v[28:31], v[40:43], v[88:91], v[28:31]
    ds_read_b64 v[116:117], v208 offset:4224
    v_mfma_f32_16x16x32_bf16 v[32:35], v[40:43], v[92:95], v[32:35]
    ds_read_b64 v[118:119], v208 offset:4240
    v_mfma_f32_16x16x32_bf16 v[12:15], v[44:47], v[68:71], v[12:15]
    ds_read_b128 v[184:187], v209 offset:2944
    v_mfma_f32_16x16x32_bf16 v[16:19], v[44:47], v[72:75], v[16:19]
    ds_read_b64 v[120:121], v208 offset:5248
    v_mfma_f32_16x16x32_bf16 v[20:23], v[44:47], v[76:79], v[20:23]
    ds_read_b64 v[122:123], v208 offset:5264
    v_mfma_f32_16x16x32_bf16 v[24:27], v[44:47], v[80:83], v[24:27]
    ds_read_b128 v[188:191], v209 offset:3456
    v_mfma_f32_16x16x32_bf16 v[28:31], v[44:47], v[84:87], v[28:31]
    ds_read_b64 v[156:157], v208 offset:6272
    v_mfma_f32_16x16x32_bf16 v[32:35], v[44:47], v[88:91], v[32:35]
    ds_read_b64 v[158:159], v208 offset:6288
    v_mfma_f32_16x16x32_bf16 v[16:19], v[48:51], v[68:71], v[16:19]
    ds_read_b128 v[192:195], v209 offset:3968
    v_mfma_f32_16x16x32_bf16 v[20:23], v[48:51], v[72:75], v[20:23]
    ds_read_b64 v[160:161], v208 offset:7296
    v_mfma_f32_16x16x32_bf16 v[24:27], v[48:51], v[76:79], v[24:27]
    ds_read_b64 v[162:163], v208 offset:7312
    v_mfma_f32_16x16x32_bf16 v[28:31], v[48:51], v[80:83], v[28:31]
    v_mfma_f32_16x16x32_bf16 v[32:35], v[48:51], v[84:87], v[32:35]
    v_mfma_f32_16x16x32_bf16 v[20:23], v[52:55], v[68:71], v[20:23]
    v_mfma_f32_16x16x32_bf16 v[24:27], v[52:55], v[72:75], v[24:27]
    v_mfma_f32_16x16x32_bf16 v[28:31], v[52:55], v[76:79], v[28:31]
    v_mfma_f32_16x16x32_bf16 v[32:35], v[52:55], v[80:83], v[32:35]
    v_mfma_f32_16x16x32_bf16 v[24:27], v[56:59], v[68:71], v[24:27]
    v_mfma_f32_16x16x32_bf16 v[28:31], v[56:59], v[72:75], v[28:31]
    v_mfma_f32_16x16x32_bf16 v[32:35], v[56:59], v[76:79], v[32:35]
    v_mfma_f32_16x16x32_bf16 v[28:31], v[60:63], v[68:71], v[28:31]
    v_mfma_f32_16x16x32_bf16 v[32:35], v[60:63], v[72:75], v[32:35]
    v_mfma_f32_16x16x32_bf16 v[32:35], v[64:67], v[68:71], v[32:35]
    s_waitcnt lgkmcnt(0)
    v_mfma_f32_16x16x32_bf16 v[4:7], v[100:103], v[164:167], v[4:7]
    ds_read_b128 v[68:71], v209 offset:320
    v_mfma_f32_16x16x32_bf16 v[8:11], v[100:103], v[168:171], v[8:11]
    ds_read_b64 v[36:37], v208 offset:256
    v_mfma_f32_16x16x32_bf16 v[12:15], v[100:103], v[172:175], v[12:15]
    ds_read_b64 v[38:39], v208 offset:272
    v_mfma_f32_16x16x32_bf16 v[16:19], v[100:103], v[176:179], v[16:19]
    ds_read_b128 v[72:75], v209 offset:832
    v_mfma_f32_16x16x32_bf16 v[20:23], v[100:103], v[180:183], v[20:23]
    ds_read_b64 v[40:41], v208 offset:1280
    v_mfma_f32_16x16x32_bf16 v[24:27], v[100:103], v[184:187], v[24:27]
    ds_read_b64 v[42:43], v208 offset:1296
    v_mfma_f32_16x16x32_bf16 v[28:31], v[100:103], v[188:191], v[28:31]
    ds_read_b128 v[76:79], v209 offset:1344
    v_mfma_f32_16x16x32_bf16 v[32:35], v[100:103], v[192:195], v[32:35]
    ds_read_b64 v[44:45], v208 offset:2304
    v_mfma_f32_16x16x32_bf16 v[8:11], v[104:107], v[164:167], v[8:11]
    ds_read_b64 v[46:47], v208 offset:2320
    v_mfma_f32_16x16x32_bf16 v[12:15], v[104:107], v[168:171], v[12:15]
    ds_read_b128 v[80:83], v209 offset:1856
    v_mfma_f32_16x16x32_bf16 v[16:19], v[104:107], v[172:175], v[16:19]
    ds_read_b64 v[48:49], v208 offset:3328
    v_mfma_f32_16x16x32_bf16 v[20:23], v[104:107], v[176:179], v[20:23]
    ds_read_b64 v[50:51], v208 offset:3344
    v_mfma_f32_16x16x32_bf16 v[24:27], v[104:107], v[180:183], v[24:27]
    ds_read_b128 v[84:87], v209 offset:2368
    v_mfma_f32_16x16x32_bf16 v[28:31], v[104:107], v[184:187], v[28:31]
    ds_read_b64 v[52:53], v208 offset:4352
    v_mfma_f32_16x16x32_bf16 v[32:35], v[104:107], v[188:191], v[32:35]
    ds_read_b64 v[54:55], v208 offset:4368
    v_mfma_f32_16x16x32_bf16 v[12:15], v[108:111], v[164:167], v[12:15]
    ds_read_b128 v[88:91], v209 offset:2880
    v_mfma_f32_16x16x32_bf16 v[16:19], v[108:111], v[168:171], v[16:19]
    ds_read_b64 v[56:57], v208 offset:5376
    v_mfma_f32_16x16x32_bf16 v[20:23], v[108:111], v[172:175], v[20:23]
    ds_read_b64 v[58:59], v208 offset:5392
    v_mfma_f32_16x16x32_bf16 v[24:27], v[108:111], v[176:179], v[24:27]
    ds_read_b128 v[92:95], v209 offset:3392
    v_mfma_f32_16x16x32_bf16 v[28:31], v[108:111], v[180:183], v[28:31]
    ds_read_b64 v[60:61], v208 offset:6400
    v_mfma_f32_16x16x32_bf16 v[32:35], v[108:111], v[184:187], v[32:35]
    ds_read_b64 v[62:63], v208 offset:6416
    v_mfma_f32_16x16x32_bf16 v[16:19], v[112:115], v[164:167], v[16:19]
    ds_read_b128 v[96:99], v209 offset:3904
    v_mfma_f32_16x16x32_bf16 v[20:23], v[112:115], v[168:171], v[20:23]
    ds_read_b64 v[64:65], v208 offset:7424
    v_mfma_f32_16x16x32_bf16 v[24:27], v[112:115], v[172:175], v[24:27]
    ds_read_b64 v[66:67], v208 offset:7440
    v_mfma_f32_16x16x32_bf16 v[28:31], v[112:115], v[176:179], v[28:31]
    v_mfma_f32_16x16x32_bf16 v[32:35], v[112:115], v[180:183], v[32:35]
    v_mfma_f32_16x16x32_bf16 v[20:23], v[116:119], v[164:167], v[20:23]
    v_mfma_f32_16x16x32_bf16 v[24:27], v[116:119], v[168:171], v[24:27]
    v_mfma_f32_16x16x32_bf16 v[28:31], v[116:119], v[172:175], v[28:31]
    v_mfma_f32_16x16x32_bf16 v[32:35], v[116:119], v[176:179], v[32:35]
    v_mfma_f32_16x16x32_bf16 v[24:27], v[120:123], v[164:167], v[24:27]
    v_mfma_f32_16x16x32_bf16 v[28:31], v[120:123], v[168:171], v[28:31]
    v_mfma_f32_16x16x32_bf16 v[32:35], v[120:123], v[172:175], v[32:35]
    v_mfma_f32_16x16x32_bf16 v[28:31], v[156:159], v[164:167], v[28:31]
    v_mfma_f32_16x16x32_bf16 v[32:35], v[156:159], v[168:171], v[32:35]
    v_mfma_f32_16x16x32_bf16 v[32:35], v[160:163], v[164:167], v[32:35]
    s_waitcnt lgkmcnt(0)
    v_mfma_f32_16x16x32_bf16 v[4:7], v[36:39], v[68:71], v[4:7]
    ds_read_b128 v[164:167], v209 offset:256
    v_mfma_f32_16x16x32_bf16 v[8:11], v[36:39], v[72:75], v[8:11]
    ds_read_b64 v[100:101], v208 offset:384
    v_mfma_f32_16x16x32_bf16 v[12:15], v[36:39], v[76:79], v[12:15]
    ds_read_b64 v[102:103], v208 offset:400
    v_mfma_f32_16x16x32_bf16 v[16:19], v[36:39], v[80:83], v[16:19]
    ds_read_b128 v[168:171], v209 offset:768
    v_mfma_f32_16x16x32_bf16 v[20:23], v[36:39], v[84:87], v[20:23]
    ds_read_b64 v[104:105], v208 offset:1408
    v_mfma_f32_16x16x32_bf16 v[24:27], v[36:39], v[88:91], v[24:27]
    ds_read_b64 v[106:107], v208 offset:1424
    v_mfma_f32_16x16x32_bf16 v[28:31], v[36:39], v[92:95], v[28:31]
    ds_read_b128 v[172:175], v209 offset:1280
    v_mfma_f32_16x16x32_bf16 v[32:35], v[36:39], v[96:99], v[32:35]
    ds_read_b64 v[108:109], v208 offset:2432
    v_mfma_f32_16x16x32_bf16 v[8:11], v[40:43], v[68:71], v[8:11]
    ds_read_b64 v[110:111], v208 offset:2448
    v_mfma_f32_16x16x32_bf16 v[12:15], v[40:43], v[72:75], v[12:15]
    ds_read_b128 v[176:179], v209 offset:1792
    v_mfma_f32_16x16x32_bf16 v[16:19], v[40:43], v[76:79], v[16:19]
    ds_read_b64 v[112:113], v208 offset:3456
    v_mfma_f32_16x16x32_bf16 v[20:23], v[40:43], v[80:83], v[20:23]
    ds_read_b64 v[114:115], v208 offset:3472
    v_mfma_f32_16x16x32_bf16 v[24:27], v[40:43], v[84:87], v[24:27]
    ds_read_b128 v[180:183], v209 offset:2304
    v_mfma_f32_16x16x32_bf16 v[28:31], v[40:43], v[88:91], v[28:31]
    ds_read_b64 v[116:117], v208 offset:4480
    v_mfma_f32_16x16x32_bf16 v[32:35], v[40:43], v[92:95], v[32:35]
    ds_read_b64 v[118:119], v208 offset:4496
    v_mfma_f32_16x16x32_bf16 v[12:15], v[44:47], v[68:71], v[12:15]
    ds_read_b128 v[184:187], v209 offset:2816
    v_mfma_f32_16x16x32_bf16 v[16:19], v[44:47], v[72:75], v[16:19]
    ds_read_b64 v[120:121], v208 offset:5504
    v_mfma_f32_16x16x32_bf16 v[20:23], v[44:47], v[76:79], v[20:23]
    ds_read_b64 v[122:123], v208 offset:5520
    v_mfma_f32_16x16x32_bf16 v[24:27], v[44:47], v[80:83], v[24:27]
    ds_read_b128 v[188:191], v209 offset:3328
    v_mfma_f32_16x16x32_bf16 v[28:31], v[44:47], v[84:87], v[28:31]
    ds_read_b64 v[156:157], v208 offset:6528
    v_mfma_f32_16x16x32_bf16 v[32:35], v[44:47], v[88:91], v[32:35]
    ds_read_b64 v[158:159], v208 offset:6544
    v_mfma_f32_16x16x32_bf16 v[16:19], v[48:51], v[68:71], v[16:19]
    ds_read_b128 v[192:195], v209 offset:3840
    v_mfma_f32_16x16x32_bf16 v[20:23], v[48:51], v[72:75], v[20:23]
    ds_read_b64 v[160:161], v208 offset:7552
    v_mfma_f32_16x16x32_bf16 v[24:27], v[48:51], v[76:79], v[24:27]
    ds_read_b64 v[162:163], v208 offset:7568
    v_mfma_f32_16x16x32_bf16 v[28:31], v[48:51], v[80:83], v[28:31]
    v_mfma_f32_16x16x32_bf16 v[32:35], v[48:51], v[84:87], v[32:35]
    v_mfma_f32_16x16x32_bf16 v[20:23], v[52:55], v[68:71], v[20:23]
    v_mfma_f32_16x16x32_bf16 v[24:27], v[52:55], v[72:75], v[24:27]
    v_mfma_f32_16x16x32_bf16 v[28:31], v[52:55], v[76:79], v[28:31]
    v_mfma_f32_16x16x32_bf16 v[32:35], v[52:55], v[80:83], v[32:35]
    v_mfma_f32_16x16x32_bf16 v[24:27], v[56:59], v[68:71], v[24:27]
    v_mfma_f32_16x16x32_bf16 v[28:31], v[56:59], v[72:75], v[28:31]
    v_mfma_f32_16x16x32_bf16 v[32:35], v[56:59], v[76:79], v[32:35]
    v_mfma_f32_16x16x32_bf16 v[28:31], v[60:63], v[68:71], v[28:31]
    v_mfma_f32_16x16x32_bf16 v[32:35], v[60:63], v[72:75], v[32:35]
    v_mfma_f32_16x16x32_bf16 v[32:35], v[64:67], v[68:71], v[32:35]
    s_waitcnt lgkmcnt(0)
    v_mfma_f32_16x16x32_bf16 v[4:7], v[100:103], v[164:167], v[4:7]
    ds_read_b128 v[68:71], v209 offset:192
    v_mfma_f32_16x16x32_bf16 v[8:11], v[100:103], v[168:171], v[8:11]
    ds_read_b64 v[36:37], v208 offset:512
    v_mfma_f32_16x16x32_bf16 v[12:15], v[100:103], v[172:175], v[12:15]
    ds_read_b64 v[38:39], v208 offset:528
    v_mfma_f32_16x16x32_bf16 v[16:19], v[100:103], v[176:179], v[16:19]
    ds_read_b128 v[72:75], v209 offset:704
    v_mfma_f32_16x16x32_bf16 v[20:23], v[100:103], v[180:183], v[20:23]
    ds_read_b64 v[40:41], v208 offset:1536
    v_mfma_f32_16x16x32_bf16 v[24:27], v[100:103], v[184:187], v[24:27]
    ds_read_b64 v[42:43], v208 offset:1552
    v_mfma_f32_16x16x32_bf16 v[28:31], v[100:103], v[188:191], v[28:31]
    ds_read_b128 v[76:79], v209 offset:1216
    v_mfma_f32_16x16x32_bf16 v[32:35], v[100:103], v[192:195], v[32:35]
    ds_read_b64 v[44:45], v208 offset:2560
    v_mfma_f32_16x16x32_bf16 v[8:11], v[104:107], v[164:167], v[8:11]
    ds_read_b64 v[46:47], v208 offset:2576
    v_mfma_f32_16x16x32_bf16 v[12:15], v[104:107], v[168:171], v[12:15]
    ds_read_b128 v[80:83], v209 offset:1728
    v_mfma_f32_16x16x32_bf16 v[16:19], v[104:107], v[172:175], v[16:19]
    ds_read_b64 v[48:49], v208 offset:3584
    v_mfma_f32_16x16x32_bf16 v[20:23], v[104:107], v[176:179], v[20:23]
    ds_read_b64 v[50:51], v208 offset:3600
    v_mfma_f32_16x16x32_bf16 v[24:27], v[104:107], v[180:183], v[24:27]
    ds_read_b128 v[84:87], v209 offset:2240
    v_mfma_f32_16x16x32_bf16 v[28:31], v[104:107], v[184:187], v[28:31]
    ds_read_b64 v[52:53], v208 offset:4608
    v_mfma_f32_16x16x32_bf16 v[32:35], v[104:107], v[188:191], v[32:35]
    ds_read_b64 v[54:55], v208 offset:4624
    v_mfma_f32_16x16x32_bf16 v[12:15], v[108:111], v[164:167], v[12:15]
    ds_read_b128 v[88:91], v209 offset:2752
    v_mfma_f32_16x16x32_bf16 v[16:19], v[108:111], v[168:171], v[16:19]
    ds_read_b64 v[56:57], v208 offset:5632
    v_mfma_f32_16x16x32_bf16 v[20:23], v[108:111], v[172:175], v[20:23]
    ds_read_b64 v[58:59], v208 offset:5648
    v_mfma_f32_16x16x32_bf16 v[24:27], v[108:111], v[176:179], v[24:27]
    ds_read_b128 v[92:95], v209 offset:3264
    v_mfma_f32_16x16x32_bf16 v[28:31], v[108:111], v[180:183], v[28:31]
    ds_read_b64 v[60:61], v208 offset:6656
    v_mfma_f32_16x16x32_bf16 v[32:35], v[108:111], v[184:187], v[32:35]
    ds_read_b64 v[62:63], v208 offset:6672
    v_mfma_f32_16x16x32_bf16 v[16:19], v[112:115], v[164:167], v[16:19]
    ds_read_b128 v[96:99], v209 offset:3776
    v_mfma_f32_16x16x32_bf16 v[20:23], v[112:115], v[168:171], v[20:23]
    ds_read_b64 v[64:65], v208 offset:7680
    v_mfma_f32_16x16x32_bf16 v[24:27], v[112:115], v[172:175], v[24:27]
    ds_read_b64 v[66:67], v208 offset:7696
    v_mfma_f32_16x16x32_bf16 v[28:31], v[112:115], v[176:179], v[28:31]
    v_mfma_f32_16x16x32_bf16 v[32:35], v[112:115], v[180:183], v[32:35]
    v_mfma_f32_16x16x32_bf16 v[20:23], v[116:119], v[164:167], v[20:23]
    v_mfma_f32_16x16x32_bf16 v[24:27], v[116:119], v[168:171], v[24:27]
    v_mfma_f32_16x16x32_bf16 v[28:31], v[116:119], v[172:175], v[28:31]
    v_mfma_f32_16x16x32_bf16 v[32:35], v[116:119], v[176:179], v[32:35]
    v_mfma_f32_16x16x32_bf16 v[24:27], v[120:123], v[164:167], v[24:27]
    v_mfma_f32_16x16x32_bf16 v[28:31], v[120:123], v[168:171], v[28:31]
    v_mfma_f32_16x16x32_bf16 v[32:35], v[120:123], v[172:175], v[32:35]
    v_mfma_f32_16x16x32_bf16 v[28:31], v[156:159], v[164:167], v[28:31]
    v_mfma_f32_16x16x32_bf16 v[32:35], v[156:159], v[168:171], v[32:35]
    v_mfma_f32_16x16x32_bf16 v[32:35], v[160:163], v[164:167], v[32:35]
    s_waitcnt lgkmcnt(0)
    v_mfma_f32_16x16x32_bf16 v[4:7], v[36:39], v[68:71], v[4:7]
    ds_read_b128 v[164:167], v209 offset:128
    v_mfma_f32_16x16x32_bf16 v[8:11], v[36:39], v[72:75], v[8:11]
    ds_read_b64 v[100:101], v208 offset:640
    v_mfma_f32_16x16x32_bf16 v[12:15], v[36:39], v[76:79], v[12:15]
    ds_read_b64 v[102:103], v208 offset:656
    v_mfma_f32_16x16x32_bf16 v[16:19], v[36:39], v[80:83], v[16:19]
    ds_read_b128 v[168:171], v209 offset:640
    v_mfma_f32_16x16x32_bf16 v[20:23], v[36:39], v[84:87], v[20:23]
    ds_read_b64 v[104:105], v208 offset:1664
    v_mfma_f32_16x16x32_bf16 v[24:27], v[36:39], v[88:91], v[24:27]
    ds_read_b64 v[106:107], v208 offset:1680
    v_mfma_f32_16x16x32_bf16 v[28:31], v[36:39], v[92:95], v[28:31]
    ds_read_b128 v[172:175], v209 offset:1152
    v_mfma_f32_16x16x32_bf16 v[32:35], v[36:39], v[96:99], v[32:35]
    ds_read_b64 v[108:109], v208 offset:2688
    v_mfma_f32_16x16x32_bf16 v[8:11], v[40:43], v[68:71], v[8:11]
    ds_read_b64 v[110:111], v208 offset:2704
    v_mfma_f32_16x16x32_bf16 v[12:15], v[40:43], v[72:75], v[12:15]
    ds_read_b128 v[176:179], v209 offset:1664
    v_mfma_f32_16x16x32_bf16 v[16:19], v[40:43], v[76:79], v[16:19]
    ds_read_b64 v[112:113], v208 offset:3712
    v_mfma_f32_16x16x32_bf16 v[20:23], v[40:43], v[80:83], v[20:23]
    ds_read_b64 v[114:115], v208 offset:3728
    v_mfma_f32_16x16x32_bf16 v[24:27], v[40:43], v[84:87], v[24:27]
    ds_read_b128 v[180:183], v209 offset:2176
    v_mfma_f32_16x16x32_bf16 v[28:31], v[40:43], v[88:91], v[28:31]
    ds_read_b64 v[116:117], v208 offset:4736
    v_mfma_f32_16x16x32_bf16 v[32:35], v[40:43], v[92:95], v[32:35]
    ds_read_b64 v[118:119], v208 offset:4752
    v_mfma_f32_16x16x32_bf16 v[12:15], v[44:47], v[68:71], v[12:15]
    ds_read_b128 v[184:187], v209 offset:2688
    v_mfma_f32_16x16x32_bf16 v[16:19], v[44:47], v[72:75], v[16:19]
    ds_read_b64 v[120:121], v208 offset:5760
    v_mfma_f32_16x16x32_bf16 v[20:23], v[44:47], v[76:79], v[20:23]
    ds_read_b64 v[122:123], v208 offset:5776
    v_mfma_f32_16x16x32_bf16 v[24:27], v[44:47], v[80:83], v[24:27]
    ds_read_b128 v[188:191], v209 offset:3200
    v_mfma_f32_16x16x32_bf16 v[28:31], v[44:47], v[84:87], v[28:31]
    ds_read_b64 v[156:157], v208 offset:6784
    v_mfma_f32_16x16x32_bf16 v[32:35], v[44:47], v[88:91], v[32:35]
    ds_read_b64 v[158:159], v208 offset:6800
    v_mfma_f32_16x16x32_bf16 v[16:19], v[48:51], v[68:71], v[16:19]
    ds_read_b128 v[192:195], v209 offset:3712
    v_mfma_f32_16x16x32_bf16 v[20:23], v[48:51], v[72:75], v[20:23]
    ds_read_b64 v[160:161], v208 offset:7808
    v_mfma_f32_16x16x32_bf16 v[24:27], v[48:51], v[76:79], v[24:27]
    ds_read_b64 v[162:163], v208 offset:7824
    v_mfma_f32_16x16x32_bf16 v[28:31], v[48:51], v[80:83], v[28:31]
    v_mfma_f32_16x16x32_bf16 v[32:35], v[48:51], v[84:87], v[32:35]
    v_mfma_f32_16x16x32_bf16 v[20:23], v[52:55], v[68:71], v[20:23]
    v_mfma_f32_16x16x32_bf16 v[24:27], v[52:55], v[72:75], v[24:27]
    v_mfma_f32_16x16x32_bf16 v[28:31], v[52:55], v[76:79], v[28:31]
    v_mfma_f32_16x16x32_bf16 v[32:35], v[52:55], v[80:83], v[32:35]
    v_mfma_f32_16x16x32_bf16 v[24:27], v[56:59], v[68:71], v[24:27]
    v_mfma_f32_16x16x32_bf16 v[28:31], v[56:59], v[72:75], v[28:31]
    v_mfma_f32_16x16x32_bf16 v[32:35], v[56:59], v[76:79], v[32:35]
    v_mfma_f32_16x16x32_bf16 v[28:31], v[60:63], v[68:71], v[28:31]
    v_mfma_f32_16x16x32_bf16 v[32:35], v[60:63], v[72:75], v[32:35]
    v_mfma_f32_16x16x32_bf16 v[32:35], v[64:67], v[68:71], v[32:35]
    s_waitcnt lgkmcnt(0)
    v_mfma_f32_16x16x32_bf16 v[4:7], v[100:103], v[164:167], v[4:7]
    ds_read_b128 v[68:71], v209 offset:64
    v_mfma_f32_16x16x32_bf16 v[8:11], v[100:103], v[168:171], v[8:11]
    ds_read_b64 v[36:37], v208 offset:768
    v_mfma_f32_16x16x32_bf16 v[12:15], v[100:103], v[172:175], v[12:15]
    ds_read_b64 v[38:39], v208 offset:784
    v_mfma_f32_16x16x32_bf16 v[16:19], v[100:103], v[176:179], v[16:19]
    ds_read_b128 v[72:75], v209 offset:576
    v_mfma_f32_16x16x32_bf16 v[20:23], v[100:103], v[180:183], v[20:23]
    ds_read_b64 v[40:41], v208 offset:1792
    v_mfma_f32_16x16x32_bf16 v[24:27], v[100:103], v[184:187], v[24:27]
    ds_read_b64 v[42:43], v208 offset:1808
    v_mfma_f32_16x16x32_bf16 v[28:31], v[100:103], v[188:191], v[28:31]
    ds_read_b128 v[76:79], v209 offset:1088
    v_mfma_f32_16x16x32_bf16 v[32:35], v[100:103], v[192:195], v[32:35]
    ds_read_b64 v[44:45], v208 offset:2816
    v_mfma_f32_16x16x32_bf16 v[8:11], v[104:107], v[164:167], v[8:11]
    ds_read_b64 v[46:47], v208 offset:2832
    v_mfma_f32_16x16x32_bf16 v[12:15], v[104:107], v[168:171], v[12:15]
    ds_read_b128 v[80:83], v209 offset:1600
    v_mfma_f32_16x16x32_bf16 v[16:19], v[104:107], v[172:175], v[16:19]
    ds_read_b64 v[48:49], v208 offset:3840
    v_mfma_f32_16x16x32_bf16 v[20:23], v[104:107], v[176:179], v[20:23]
    ds_read_b64 v[50:51], v208 offset:3856
    v_mfma_f32_16x16x32_bf16 v[24:27], v[104:107], v[180:183], v[24:27]
    ds_read_b128 v[84:87], v209 offset:2112
    v_mfma_f32_16x16x32_bf16 v[28:31], v[104:107], v[184:187], v[28:31]
    ds_read_b64 v[52:53], v208 offset:4864
    v_mfma_f32_16x16x32_bf16 v[32:35], v[104:107], v[188:191], v[32:35]
    ds_read_b64 v[54:55], v208 offset:4880
    v_mfma_f32_16x16x32_bf16 v[12:15], v[108:111], v[164:167], v[12:15]
    ds_read_b128 v[88:91], v209 offset:2624
    v_mfma_f32_16x16x32_bf16 v[16:19], v[108:111], v[168:171], v[16:19]
    ds_read_b64 v[56:57], v208 offset:5888
    v_mfma_f32_16x16x32_bf16 v[20:23], v[108:111], v[172:175], v[20:23]
    ds_read_b64 v[58:59], v208 offset:5904
    v_mfma_f32_16x16x32_bf16 v[24:27], v[108:111], v[176:179], v[24:27]
    ds_read_b128 v[92:95], v209 offset:3136
    v_mfma_f32_16x16x32_bf16 v[28:31], v[108:111], v[180:183], v[28:31]
    ds_read_b64 v[60:61], v208 offset:6912
    v_mfma_f32_16x16x32_bf16 v[32:35], v[108:111], v[184:187], v[32:35]
    ds_read_b64 v[62:63], v208 offset:6928
    v_mfma_f32_16x16x32_bf16 v[16:19], v[112:115], v[164:167], v[16:19]
    ds_read_b128 v[96:99], v209 offset:3648
    v_mfma_f32_16x16x32_bf16 v[20:23], v[112:115], v[168:171], v[20:23]
    ds_read_b64 v[64:65], v208 offset:7936
    v_mfma_f32_16x16x32_bf16 v[24:27], v[112:115], v[172:175], v[24:27]
    ds_read_b64 v[66:67], v208 offset:7952
    v_mfma_f32_16x16x32_bf16 v[28:31], v[112:115], v[176:179], v[28:31]
    v_mfma_f32_16x16x32_bf16 v[32:35], v[112:115], v[180:183], v[32:35]
    v_mfma_f32_16x16x32_bf16 v[20:23], v[116:119], v[164:167], v[20:23]
    v_mfma_f32_16x16x32_bf16 v[24:27], v[116:119], v[168:171], v[24:27]
    v_mfma_f32_16x16x32_bf16 v[28:31], v[116:119], v[172:175], v[28:31]
    v_mfma_f32_16x16x32_bf16 v[32:35], v[116:119], v[176:179], v[32:35]
    v_mfma_f32_16x16x32_bf16 v[24:27], v[120:123], v[164:167], v[24:27]
    v_mfma_f32_16x16x32_bf16 v[28:31], v[120:123], v[168:171], v[28:31]
    v_mfma_f32_16x16x32_bf16 v[32:35], v[120:123], v[172:175], v[32:35]
    v_mfma_f32_16x16x32_bf16 v[28:31], v[156:159], v[164:167], v[28:31]
    v_mfma_f32_16x16x32_bf16 v[32:35], v[156:159], v[168:171], v[32:35]
    v_mfma_f32_16x16x32_bf16 v[32:35], v[160:163], v[164:167], v[32:35]
    s_waitcnt lgkmcnt(0)
    v_mfma_f32_16x16x32_bf16 v[4:7], v[36:39], v[68:71], v[4:7]
    ds_read_b128 v[164:167], v209 offset:0
    v_mfma_f32_16x16x32_bf16 v[8:11], v[36:39], v[72:75], v[8:11]
    ds_read_b64 v[100:101], v208 offset:896
    v_mfma_f32_16x16x32_bf16 v[12:15], v[36:39], v[76:79], v[12:15]
    ds_read_b64 v[102:103], v208 offset:912
    v_mfma_f32_16x16x32_bf16 v[16:19], v[36:39], v[80:83], v[16:19]
    ds_read_b128 v[168:171], v209 offset:512
    v_mfma_f32_16x16x32_bf16 v[20:23], v[36:39], v[84:87], v[20:23]
    ds_read_b64 v[104:105], v208 offset:1920
    v_mfma_f32_16x16x32_bf16 v[24:27], v[36:39], v[88:91], v[24:27]
    ds_read_b64 v[106:107], v208 offset:1936
    v_mfma_f32_16x16x32_bf16 v[28:31], v[36:39], v[92:95], v[28:31]
    ds_read_b128 v[172:175], v209 offset:1024
    v_mfma_f32_16x16x32_bf16 v[32:35], v[36:39], v[96:99], v[32:35]
    ds_read_b64 v[108:109], v208 offset:2944
    v_mfma_f32_16x16x32_bf16 v[8:11], v[40:43], v[68:71], v[8:11]
    ds_read_b64 v[110:111], v208 offset:2960
    v_mfma_f32_16x16x32_bf16 v[12:15], v[40:43], v[72:75], v[12:15]
    ds_read_b128 v[176:179], v209 offset:1536
    v_mfma_f32_16x16x32_bf16 v[16:19], v[40:43], v[76:79], v[16:19]
    ds_read_b64 v[112:113], v208 offset:3968
    v_mfma_f32_16x16x32_bf16 v[20:23], v[40:43], v[80:83], v[20:23]
    ds_read_b64 v[114:115], v208 offset:3984
    v_mfma_f32_16x16x32_bf16 v[24:27], v[40:43], v[84:87], v[24:27]
    ds_read_b128 v[180:183], v209 offset:2048
    v_mfma_f32_16x16x32_bf16 v[28:31], v[40:43], v[88:91], v[28:31]
    ds_read_b64 v[116:117], v208 offset:4992
    v_mfma_f32_16x16x32_bf16 v[32:35], v[40:43], v[92:95], v[32:35]
    ds_read_b64 v[118:119], v208 offset:5008
    v_mfma_f32_16x16x32_bf16 v[12:15], v[44:47], v[68:71], v[12:15]
    ds_read_b128 v[184:187], v209 offset:2560
    v_mfma_f32_16x16x32_bf16 v[16:19], v[44:47], v[72:75], v[16:19]
    ds_read_b64 v[120:121], v208 offset:6016
    v_mfma_f32_16x16x32_bf16 v[20:23], v[44:47], v[76:79], v[20:23]
    ds_read_b64 v[122:123], v208 offset:6032
    v_mfma_f32_16x16x32_bf16 v[24:27], v[44:47], v[80:83], v[24:27]
    ds_read_b128 v[188:191], v209 offset:3072
    v_mfma_f32_16x16x32_bf16 v[28:31], v[44:47], v[84:87], v[28:31]
    ds_read_b64 v[156:157], v208 offset:7040
    v_mfma_f32_16x16x32_bf16 v[32:35], v[44:47], v[88:91], v[32:35]
    ds_read_b64 v[158:159], v208 offset:7056
    v_mfma_f32_16x16x32_bf16 v[16:19], v[48:51], v[68:71], v[16:19]
    ds_read_b128 v[192:195], v209 offset:3584
    v_mfma_f32_16x16x32_bf16 v[20:23], v[48:51], v[72:75], v[20:23]
    ds_read_b64 v[160:161], v208 offset:8064
    v_mfma_f32_16x16x32_bf16 v[24:27], v[48:51], v[76:79], v[24:27]
    ds_read_b64 v[162:163], v208 offset:8080
    v_mfma_f32_16x16x32_bf16 v[28:31], v[48:51], v[80:83], v[28:31]
    v_mfma_f32_16x16x32_bf16 v[32:35], v[48:51], v[84:87], v[32:35]
    v_mfma_f32_16x16x32_bf16 v[20:23], v[52:55], v[68:71], v[20:23]
    v_mfma_f32_16x16x32_bf16 v[24:27], v[52:55], v[72:75], v[24:27]
    v_mfma_f32_16x16x32_bf16 v[28:31], v[52:55], v[76:79], v[28:31]
    v_mfma_f32_16x16x32_bf16 v[32:35], v[52:55], v[80:83], v[32:35]
    v_mfma_f32_16x16x32_bf16 v[24:27], v[56:59], v[68:71], v[24:27]
    v_mfma_f32_16x16x32_bf16 v[28:31], v[56:59], v[72:75], v[28:31]
    v_mfma_f32_16x16x32_bf16 v[32:35], v[56:59], v[76:79], v[32:35]
    v_mfma_f32_16x16x32_bf16 v[28:31], v[60:63], v[68:71], v[28:31]
    v_mfma_f32_16x16x32_bf16 v[32:35], v[60:63], v[72:75], v[32:35]
    v_mfma_f32_16x16x32_bf16 v[32:35], v[64:67], v[68:71], v[32:35]
    s_waitcnt lgkmcnt(0)
    v_mfma_f32_16x16x32_bf16 v[4:7], v[100:103], v[164:167], v[4:7]
    v_mfma_f32_16x16x32_bf16 v[8:11], v[100:103], v[168:171], v[8:11]
    v_mfma_f32_16x16x32_bf16 v[8:11], v[104:107], v[164:167], v[8:11]
    v_mfma_f32_16x16x32_bf16 v[12:15], v[100:103], v[172:175], v[12:15]
    v_mfma_f32_16x16x32_bf16 v[12:15], v[104:107], v[168:171], v[12:15]
    v_mfma_f32_16x16x32_bf16 v[12:15], v[108:111], v[164:167], v[12:15]
    s_nop 2
    v_cvt_pk_bf16_f32 v36, v4, v5
    v_cvt_pk_bf16_f32 v37, v6, v7
    buffer_store_dwordx2 v[36:37], v234, s[40:43], s52 offen offset:0 sc1
    v_mfma_f32_16x16x32_bf16 v[16:19], v[100:103], v[176:179], v[16:19]
    v_mfma_f32_16x16x32_bf16 v[16:19], v[104:107], v[172:175], v[16:19]
    v_mfma_f32_16x16x32_bf16 v[16:19], v[108:111], v[168:171], v[16:19]
    v_mfma_f32_16x16x32_bf16 v[16:19], v[112:115], v[164:167], v[16:19]
    v_cvt_pk_bf16_f32 v40, v8, v9
    v_cvt_pk_bf16_f32 v41, v10, v11
    buffer_store_dwordx2 v[40:41], v234, s[40:43], s52 offen offset:512 sc1
    v_mfma_f32_16x16x32_bf16 v[20:23], v[100:103], v[180:183], v[20:23]
    v_mfma_f32_16x16x32_bf16 v[20:23], v[104:107], v[176:179], v[20:23]
    v_mfma_f32_16x16x32_bf16 v[20:23], v[108:111], v[172:175], v[20:23]
    v_mfma_f32_16x16x32_bf16 v[20:23], v[112:115], v[168:171], v[20:23]
    v_mfma_f32_16x16x32_bf16 v[20:23], v[116:119], v[164:167], v[20:23]
    v_cvt_pk_bf16_f32 v44, v12, v13
    v_cvt_pk_bf16_f32 v45, v14, v15
    buffer_store_dwordx2 v[44:45], v234, s[40:43], s52 offen offset:1024 sc1
    v_mfma_f32_16x16x32_bf16 v[24:27], v[100:103], v[184:187], v[24:27]
    v_mfma_f32_16x16x32_bf16 v[24:27], v[104:107], v[180:183], v[24:27]
    v_mfma_f32_16x16x32_bf16 v[24:27], v[108:111], v[176:179], v[24:27]
    v_mfma_f32_16x16x32_bf16 v[24:27], v[112:115], v[172:175], v[24:27]
    v_mfma_f32_16x16x32_bf16 v[24:27], v[116:119], v[168:171], v[24:27]
    v_mfma_f32_16x16x32_bf16 v[24:27], v[120:123], v[164:167], v[24:27]
    v_cvt_pk_bf16_f32 v48, v16, v17
    v_cvt_pk_bf16_f32 v49, v18, v19
    buffer_store_dwordx2 v[48:49], v234, s[40:43], s52 offen offset:1536 sc1
    v_mfma_f32_16x16x32_bf16 v[28:31], v[100:103], v[188:191], v[28:31]
    v_mfma_f32_16x16x32_bf16 v[28:31], v[104:107], v[184:187], v[28:31]
    v_mfma_f32_16x16x32_bf16 v[28:31], v[108:111], v[180:183], v[28:31]
    v_mfma_f32_16x16x32_bf16 v[28:31], v[112:115], v[176:179], v[28:31]
    v_mfma_f32_16x16x32_bf16 v[28:31], v[116:119], v[172:175], v[28:31]
    v_mfma_f32_16x16x32_bf16 v[28:31], v[120:123], v[168:171], v[28:31]
    v_mfma_f32_16x16x32_bf16 v[28:31], v[156:159], v[164:167], v[28:31]
    v_cvt_pk_bf16_f32 v52, v20, v21
    v_cvt_pk_bf16_f32 v53, v22, v23
    buffer_store_dwordx2 v[52:53], v234, s[40:43], s52 offen offset:2048 sc1
    v_mfma_f32_16x16x32_bf16 v[32:35], v[100:103], v[192:195], v[32:35]
    v_mfma_f32_16x16x32_bf16 v[32:35], v[104:107], v[188:191], v[32:35]
    v_mfma_f32_16x16x32_bf16 v[32:35], v[108:111], v[184:187], v[32:35]
    v_mfma_f32_16x16x32_bf16 v[32:35], v[112:115], v[180:183], v[32:35]
    v_mfma_f32_16x16x32_bf16 v[32:35], v[116:119], v[176:179], v[32:35]
    v_mfma_f32_16x16x32_bf16 v[32:35], v[120:123], v[172:175], v[32:35]
    v_mfma_f32_16x16x32_bf16 v[32:35], v[156:159], v[168:171], v[32:35]
    v_mfma_f32_16x16x32_bf16 v[32:35], v[160:163], v[164:167], v[32:35]
    v_cvt_pk_bf16_f32 v56, v24, v25
    v_cvt_pk_bf16_f32 v57, v26, v27
    buffer_store_dwordx2 v[56:57], v234, s[40:43], s52 offen offset:2560 sc1
    v_cvt_pk_bf16_f32 v60, v28, v29
    v_cvt_pk_bf16_f32 v61, v30, v31
    buffer_store_dwordx2 v[60:61], v234, s[40:43], s52 offen offset:3072 sc1
    s_nop 1
    v_cvt_pk_bf16_f32 v64, v32, v33
    v_cvt_pk_bf16_f32 v65, v34, v35
    buffer_store_dwordx2 v[64:65], v234, s[40:43], s52 offen offset:3584 sc1
F_NOCONV:
    v_mov_b32 v4, 0
    v_mov_b32 v5, 0
    v_mov_b32 v6, 0
    v_mov_b32 v7, 0
    v_mov_b32 v8, 0
    v_mov_b32 v9, 0
    v_mov_b32 v10, 0
    v_mov_b32 v11, 0
    v_mov_b32 v12, 0
    v_mov_b32 v13, 0
    v_mov_b32 v14, 0
    v_mov_b32 v15, 0
    v_mov_b32 v16, 0
    v_mov_b32 v17, 0
    v_mov_b32 v18, 0
    v_mov_b32 v19, 0
    v_mov_b32 v20, 0
    v_mov_b32 v21, 0
    v_mov_b32 v22, 0
    v_mov_b32 v23, 0
    v_mov_b32 v24, 0
    v_mov_b32 v25, 0
    v_mov_b32 v26, 0
    v_mov_b32 v27, 0
    v_mov_b32 v28, 0
    v_mov_b32 v29, 0
    v_mov_b32 v30, 0
    v_mov_b32 v31, 0
    v_mov_b32 v32, 0
    v_mov_b32 v33, 0
    v_mov_b32 v34, 0
    v_mov_b32 v35, 0
    v_mov_b32 v76, 0
    v_mov_b32 v77, 0
    v_mov_b32 v78, 0
    v_mov_b32 v79, 0
    v_mov_b32 v80, 0
    v_mov_b32 v81, 0
    v_mov_b32 v82, 0
    v_mov_b32 v83, 0
    v_mov_b32 v116, 0
    v_mov_b32 v117, 0
    v_mov_b32 v118, 0
    v_mov_b32 v119, 0
    v_mov_b32 v120, 0
    v_mov_b32 v121, 0
    v_mov_b32 v122, 0
    v_mov_b32 v123, 0
    v_mov_b32 v88, 0
    v_mov_b32 v89, 0
    v_mov_b32 v94, 0
    v_mov_b32 v95, 0
    s_mul_i32 s52, s80, 81920
    s_mul_i32 s53, s84, 1280
    s_add_u32 s52, s52, s53
    s_add_u32 s40, s28, s52
    s_addc_u32 s41, s29, 0
    s_mov_b32 s42, 2560
    s_mov_b32 s43, 0x00020000
    v_mov_b32 v1, 163792
    s_mov_b32 s89, 20000000
LW_25:
    ds_read_b32 v2, v1
    s_sub_u32 s89, s89, 1
    s_cbranch_scc1 LE_26
    s_waitcnt lgkmcnt(0)
    v_readfirstlane_b32 s52, v2
    s_nop 0
    s_cmp_ge_u32 s52, 1
    s_cbranch_scc0 LW_25
LE_26:
    s_add_u32 m0, s62, 0
    s_nop 0
    buffer_load_dwordx4 v136, s[32:35], s60 offen sc1 lds
    buffer_load_dwordx4 v136, s[32:35], s60 offen offset:1024 sc1 lds
    buffer_load_dwordx4 v136, s[32:35], s60 offen offset:1536 sc1 lds
    s_add_u32 s60, s60, 10240
    buffer_load_dwordx2 v[84:85], v132, s[40:43], 0 offen offset:0 sc1
    buffer_load_dwordx2 v[86:87], v132, s[40:43], 0 offen offset:256 sc1
    buffer_load_dwordx2 v[90:91], v132, s[40:43], 0 offen offset:1280 sc1
    buffer_load_dwordx2 v[92:93], v132, s[40:43], 0 offen offset:1536 sc1
    s_mov_b32 exec_hi, 0
    buffer_load_dwordx2 v[88:89], v132, s[40:43], 0 offen offset:1024 sc1
    buffer_load_dwordx2 v[94:95], v132, s[40:43], 0 offen offset:2304 sc1
    s_mov_b64 exec, -1
    s_add_u32 m0, s62, 10304
    s_nop 0
    buffer_load_dwordx4 v136, s[32:35], s60 offen sc1 lds
    buffer_load_dwordx4 v136, s[32:35], s60 offen offset:1024 sc1 lds
    buffer_load_dwordx4 v136, s[32:35], s60 offen offset:1536 sc1 lds
    s_add_u32 s60, s60, 10240
    v_mov_b32 v140, 0x3f80
    v_mov_b32 v141, 0
    v_mov_b32 v142, 0
    v_mov_b32 v143, 0
    v_mov_b32 v1, s62
    s_mov_b64 exec, 1
    ds_write_b128 v1, v[140:143] offset:2560
    ds_write_b128 v1, v[140:143] offset:12864
    ds_write_b128 v1, v[140:143] offset:23168
    ds_write_b128 v1, v[140:143] offset:33472
    s_mov_b64 exec, -1
    s_waitcnt vmcnt(0) lgkmcnt(0)
    v_mov_b32 v1, 163804
    v_mov_b32 v2, 1
    s_mov_b64 exec, 1
    ds_add_u32 v1, v2
    s_mov_b64 exec, -1
    v_mov_b32 v1, 163804
    s_mov_b32 s89, 20000000
LW_27:
    ds_read_b32 v2, v1
    s_sub_u32 s89, s89, 1
    s_cbranch_scc1 LE_28
    s_waitcnt lgkmcnt(0)
    v_readfirstlane_b32 s52, v2
    s_nop 0
    s_cmp_ge_u32 s52, 4
    s_cbranch_scc0 LW_27
LE_28:
    v_mov_b32 v1, 163796
    s_mov_b32 s89, 20000000
LW_29:
    ds_read_b32 v2, v1
    s_sub_u32 s89, s89, 1
    s_cbranch_scc1 LE_30
    s_waitcnt lgkmcnt(0)
    v_readfirstlane_b32 s52, v2
    s_nop 0
    s_cmp_ge_u32 s52, 4
    s_cbranch_scc0 LW_29
LE_30:
F_ATT:
    ds_read_b64 v[96:97], v124 offset:0
    ds_read_b64 v[98:99], v124 offset:256
    ds_read_b64 v[100:101], v125 offset:1024
    ds_read_b64 v[102:103], v124 offset:2576
    ds_read_b64 v[104:105], v124 offset:2832
    ds_read_b64 v[106:107], v125 offset:3600
    s_waitcnt lgkmcnt(0)
    v_mfma_f32_32x32x16_bf16 v[36:51], v[96:99], v[84:87], 0
    v_mfma_f32_32x32x8_bf16 v[36:51], v[100:101], v[88:89], v[36:51]
    v_mov_b32 v184, -1
    v_mov_b32 v185, -1
    v_mov_b32 v186, -1
    v_mov_b32 v187, -1
    v_mov_b32 v188, -1
    v_mov_b32 v189, -1
    buffer_store_dwordx4 v[184:187], v232, s[36:39], s48 offen sc1
    s_mov_b32 exec_hi, 0
    buffer_store_dwordx2 v[188:189], v233, s[36:39], s49 offen sc1
    s_mov_b64 exec, -1
    s_add_u32 m0, s62, 20608
    s_nop 0
    buffer_load_dwordx4 v136, s[32:35], s60 offen sc1 lds
    buffer_load_dwordx4 v136, s[32:35], s60 offen offset:1024 sc1 lds
    buffer_load_dwordx4 v136, s[32:35], s60 offen offset:1536 sc1 lds
    s_add_u32 s60, s60, 10240
    s_branch PB_LOOP
.p2align 6
PB_LOOP:
    v_mfma_f32_32x32x16_bf16 v[52:67], v[96:99], v[90:93], 0
    v_exp_f32 v36, v36
    v_exp_f32 v37, v37
    v_exp_f32 v38, v38
    v_exp_f32 v39, v39
    v_cvt_pk_bf16_f32 v68, v36, v37
    v_exp_f32 v40, v40
    ds_read_b64_tr_b16 v[108:109], v126 offset:0
    ds_read_b64_tr_b16 v[110:111], v127 offset:0
    v_mfma_f32_32x32x16_bf16 v[20:35], v[116:119], v[76:79], v[20:35]
    v_exp_f32 v41, v41
    v_cvt_pk_bf16_f32 v69, v38, v39
    v_exp_f32 v42, v42
    v_exp_f32 v43, v43
    v_cvt_pk_bf16_f32 v70, v40, v41
    v_exp_f32 v44, v44
    ds_read_b64_tr_b16 v[112:113], v128 offset:0
    v_mfma_f32_32x32x8_bf16 v[52:67], v[100:101], v[94:95], v[52:67]
    v_exp_f32 v45, v45
    v_cvt_pk_bf16_f32 v71, v42, v43
    v_exp_f32 v46, v46
    v_exp_f32 v47, v47
    v_cvt_pk_bf16_f32 v72, v44, v45
    v_exp_f32 v48, v48
    ds_read_b64_tr_b16 v[114:115], v129 offset:0
    v_mfma_f32_32x32x16_bf16 v[20:35], v[120:123], v[80:83], v[20:35]
    v_exp_f32 v49, v49
    v_cvt_pk_bf16_f32 v73, v46, v47
    v_exp_f32 v50, v50
    v_exp_f32 v51, v51
    v_cvt_pk_bf16_f32 v74, v48, v49
    v_cvt_pk_bf16_f32 v75, v50, v51
    s_waitcnt lgkmcnt(0)
    v_mfma_f32_32x32x16_bf16 v[36:51], v[102:105], v[84:87], 0
    v_exp_f32 v52, v52
    v_exp_f32 v53, v53
    v_exp_f32 v54, v54
    v_exp_f32 v55, v55
    v_cvt_pk_bf16_f32 v76, v52, v53
    v_exp_f32 v56, v56
    ds_read_b64 v[96:97], v124 offset:5152
    v_mfma_f32_32x32x16_bf16 v[4:19], v[108:111], v[68:71], v[4:19]
    v_exp_f32 v57, v57
    v_cvt_pk_bf16_f32 v77, v54, v55
    v_exp_f32 v58, v58
    v_exp_f32 v59, v59
    v_cvt_pk_bf16_f32 v78, v56, v57
    v_exp_f32 v60, v60
    ds_read_b64 v[98:99], v124 offset:5408
    v_mfma_f32_32x32x8_bf16 v[36:51], v[106:107], v[88:89], v[36:51]
    v_exp_f32 v61, v61
    v_cvt_pk_bf16_f32 v79, v58, v59
    v_exp_f32 v62, v62
    v_exp_f32 v63, v63
    v_cvt_pk_bf16_f32 v80, v60, v61
    v_exp_f32 v64, v64
    ds_read_b64 v[100:101], v125 offset:6176
    v_mfma_f32_32x32x16_bf16 v[4:19], v[112:115], v[72:75], v[4:19]
    v_exp_f32 v65, v65
    v_cvt_pk_bf16_f32 v81, v62, v63
    v_exp_f32 v66, v66
    v_exp_f32 v67, v67
    v_cvt_pk_bf16_f32 v82, v64, v65
    v_cvt_pk_bf16_f32 v83, v66, v67
    v_mfma_f32_32x32x16_bf16 v[52:67], v[102:105], v[90:93], 0
    v_exp_f32 v36, v36
    v_exp_f32 v37, v37
    v_exp_f32 v38, v38
    v_exp_f32 v39, v39
    v_cvt_pk_bf16_f32 v68, v36, v37
    v_exp_f32 v40, v40
    ds_read_b32 v139, v137
    ds_read_b32 v130, v131
    ds_read_b64_tr_b16 v[116:117], v126 offset:2576
    ds_read_b64_tr_b16 v[118:119], v127 offset:2576
    v_mfma_f32_32x32x16_bf16 v[20:35], v[108:111], v[76:79], v[20:35]
    v_exp_f32 v41, v41
    v_cvt_pk_bf16_f32 v69, v38, v39
    v_exp_f32 v42, v42
    v_exp_f32 v43, v43
    v_cvt_pk_bf16_f32 v70, v40, v41
    v_exp_f32 v44, v44
    ds_read_b64_tr_b16 v[120:121], v128 offset:2576
    v_mfma_f32_32x32x8_bf16 v[52:67], v[106:107], v[94:95], v[52:67]
    v_exp_f32 v45, v45
    v_cvt_pk_bf16_f32 v71, v42, v43
    v_exp_f32 v46, v46
    v_exp_f32 v47, v47
    v_cvt_pk_bf16_f32 v72, v44, v45
    v_exp_f32 v48, v48
    ds_read_b64_tr_b16 v[122:123], v129 offset:2576
    v_mfma_f32_32x32x16_bf16 v[20:35], v[112:115], v[80:83], v[20:35]
    v_exp_f32 v49, v49
    v_cvt_pk_bf16_f32 v73, v46, v47
    v_exp_f32 v50, v50
    v_exp_f32 v51, v51
    v_cvt_pk_bf16_f32 v74, v48, v49
    v_cvt_pk_bf16_f32 v75, v50, v51
    s_waitcnt lgkmcnt(0)
    v_mfma_f32_32x32x16_bf16 v[36:51], v[96:99], v[84:87], 0
    v_exp_f32 v52, v52
    v_readfirstlane_b32 s52, v139
    v_exp_f32 v53, v53
    v_readfirstlane_b32 s85, v130
    v_exp_f32 v54, v54
    v_exp_f32 v55, v55
    v_cvt_pk_bf16_f32 v76, v52, v53
    v_exp_f32 v56, v56
    s_cmp_ge_u32 s52, s61
    s_cbranch_scc0 PB_SPIN0
PB_SPUN0:
    ds_read_b64 v[102:103], v124 offset:7728
    v_mfma_f32_32x32x16_bf16 v[4:19], v[116:119], v[68:71], v[4:19]
    v_exp_f32 v57, v57
    v_cvt_pk_bf16_f32 v77, v54, v55
    v_exp_f32 v58, v58
    v_exp_f32 v59, v59
    v_cvt_pk_bf16_f32 v78, v56, v57
    v_exp_f32 v60, v60
    ds_read_b64 v[104:105], v124 offset:7984
    s_add_u32 m0, s62, 30912
    s_nop 0
    buffer_load_dwordx4 v136, s[32:35], s60 offen sc1 lds
    buffer_load_dwordx4 v136, s[32:35], s60 offen offset:1024 sc1 lds
    buffer_load_dwordx4 v136, s[32:35], s60 offen offset:1536 sc1 lds
    s_add_u32 s60, s60, 10240
    v_mfma_f32_32x32x8_bf16 v[36:51], v[100:101], v[88:89], v[36:51]
    v_exp_f32 v61, v61
    v_cvt_pk_bf16_f32 v79, v58, v59
    v_exp_f32 v62, v62
    v_exp_f32 v63, v63
    v_cvt_pk_bf16_f32 v80, v60, v61
    v_exp_f32 v64, v64
    ds_read_b64 v[106:107], v125 offset:8752
    s_cmp_gt_u32 s85, s61
    s_setprio 0
    s_cbranch_scc0 PB_PR0
    s_setprio 1
PB_PR0:
    v_mfma_f32_32x32x16_bf16 v[4:19], v[120:123], v[72:75], v[4:19]
    v_exp_f32 v65, v65
    v_cvt_pk_bf16_f32 v81, v62, v63
    v_exp_f32 v66, v66
    v_exp_f32 v67, v67
    v_cvt_pk_bf16_f32 v82, v64, v65
    v_cvt_pk_bf16_f32 v83, v66, v67
    v_mfma_f32_32x32x16_bf16 v[52:67], v[96:99], v[90:93], 0
    v_exp_f32 v36, v36
    v_exp_f32 v37, v37
    v_exp_f32 v38, v38
    v_exp_f32 v39, v39
    v_cvt_pk_bf16_f32 v68, v36, v37
    v_exp_f32 v40, v40
    ds_read_b64_tr_b16 v[108:109], v126 offset:5152
    ds_read_b64_tr_b16 v[110:111], v127 offset:5152
    v_mfma_f32_32x32x16_bf16 v[20:35], v[116:119], v[76:79], v[20:35]
    v_exp_f32 v41, v41
    v_cvt_pk_bf16_f32 v69, v38, v39
    v_exp_f32 v42, v42
    v_exp_f32 v43, v43
    v_cvt_pk_bf16_f32 v70, v40, v41
    v_exp_f32 v44, v44
    ds_read_b64_tr_b16 v[112:113], v128 offset:5152
    v_mfma_f32_32x32x8_bf16 v[52:67], v[100:101], v[94:95], v[52:67]
    v_exp_f32 v45, v45
    v_cvt_pk_bf16_f32 v71, v42, v43
    v_exp_f32 v46, v46
    v_exp_f32 v47, v47
    v_cvt_pk_bf16_f32 v72, v44, v45
    v_exp_f32 v48, v48
    ds_read_b64_tr_b16 v[114:115], v129 offset:5152
    v_mfma_f32_32x32x16_bf16 v[20:35], v[120:123], v[80:83], v[20:35]
    v_exp_f32 v49, v49
    v_cvt_pk_bf16_f32 v73, v46, v47
    v_exp_f32 v50, v50
    v_exp_f32 v51, v51
    v_cvt_pk_bf16_f32 v74, v48, v49
    v_cvt_pk_bf16_f32 v75, v50, v51
    s_waitcnt lgkmcnt(0)
    v_mfma_f32_32x32x16_bf16 v[36:51], v[102:105], v[84:87], 0
    v_exp_f32 v52, v52
    v_exp_f32 v53, v53
    v_exp_f32 v54, v54
    v_exp_f32 v55, v55
    v_cvt_pk_bf16_f32 v76, v52, v53
    v_exp_f32 v56, v56
    ds_read_b64 v[96:97], v124 offset:10304
    v_mfma_f32_32x32x16_bf16 v[4:19], v[108:111], v[68:71], v[4:19]
    v_exp_f32 v57, v57
    v_cvt_pk_bf16_f32 v77, v54, v55
    v_exp_f32 v58, v58
    v_exp_f32 v59, v59
    v_cvt_pk_bf16_f32 v78, v56, v57
    v_exp_f32 v60, v60
    ds_read_b64 v[98:99], v124 offset:10560
    v_mfma_f32_32x32x8_bf16 v[36:51], v[106:107], v[88:89], v[36:51]
    v_exp_f32 v61, v61
    v_cvt_pk_bf16_f32 v79, v58, v59
    v_exp_f32 v62, v62
    v_exp_f32 v63, v63
    v_cvt_pk_bf16_f32 v80, v60, v61
    v_exp_f32 v64, v64
    ds_read_b64 v[100:101], v125 offset:11328
    v_mfma_f32_32x32x16_bf16 v[4:19], v[112:115], v[72:75], v[4:19]
    v_exp_f32 v65, v65
    v_cvt_pk_bf16_f32 v81, v62, v63
    v_exp_f32 v66, v66
    v_exp_f32 v67, v67
    v_cvt_pk_bf16_f32 v82, v64, v65
    v_cvt_pk_bf16_f32 v83, v66, v67
    v_mfma_f32_32x32x16_bf16 v[52:67], v[102:105], v[90:93], 0
    v_exp_f32 v36, v36
    v_exp_f32 v37, v37
    v_exp_f32 v38, v38
    v_exp_f32 v39, v39
    v_cvt_pk_bf16_f32 v68, v36, v37
    v_exp_f32 v40, v40
    ds_read_b64_tr_b16 v[116:117], v126 offset:7728
    ds_read_b64_tr_b16 v[118:119], v127 offset:7728
    v_mfma_f32_32x32x16_bf16 v[20:35], v[108:111], v[76:79], v[20:35]
    v_exp_f32 v41, v41
    v_cvt_pk_bf16_f32 v69, v38, v39
    v_exp_f32 v42, v42
    v_exp_f32 v43, v43
    v_cvt_pk_bf16_f32 v70, v40, v41
    v_exp_f32 v44, v44
    ds_read_b64_tr_b16 v[120:121], v128 offset:7728
    v_mfma_f32_32x32x8_bf16 v[52:67], v[106:107], v[94:95], v[52:67]
    v_exp_f32 v45, v45
    v_cvt_pk_bf16_f32 v71, v42, v43
    v_exp_f32 v46, v46
    v_exp_f32 v47, v47
    v_cvt_pk_bf16_f32 v72, v44, v45
    v_exp_f32 v48, v48
    ds_read_b64_tr_b16 v[122:123], v129 offset:7728
    v_mfma_f32_32x32x16_bf16 v[20:35], v[112:115], v[80:83], v[20:35]
    v_exp_f32 v49, v49
    v_cvt_pk_bf16_f32 v73, v46, v47
    v_exp_f32 v50, v50
    v_exp_f32 v51, v51
    v_cvt_pk_bf16_f32 v74, v48, v49
    v_cvt_pk_bf16_f32 v75, v50, v51
    s_waitcnt lgkmcnt(0)
    v_mfma_f32_32x32x16_bf16 v[36:51], v[96:99], v[84:87], 0
    v_exp_f32 v52, v52
    v_exp_f32 v53, v53
    v_exp_f32 v54, v54
    v_exp_f32 v55, v55
    v_cvt_pk_bf16_f32 v76, v52, v53
    v_exp_f32 v56, v56
    ds_read_b64 v[102:103], v124 offset:12880
    v_mfma_f32_32x32x16_bf16 v[4:19], v[116:119], v[68:71], v[4:19]
    v_exp_f32 v57, v57
    v_cvt_pk_bf16_f32 v77, v54, v55
    v_exp_f32 v58, v58
    v_exp_f32 v59, v59
    v_cvt_pk_bf16_f32 v78, v56, v57
    v_exp_f32 v60, v60
    ds_read_b64 v[104:105], v124 offset:13136
    s_waitcnt vmcnt(3)
    s_mov_b64 exec, 1
    ds_add_u32 v137, v138
    s_mov_b64 exec, -1
    s_add_u32 s61, s61, 4
    v_mfma_f32_32x32x8_bf16 v[36:51], v[100:101], v[88:89], v[36:51]
    v_exp_f32 v61, v61
    v_cvt_pk_bf16_f32 v79, v58, v59
    v_exp_f32 v62, v62
    v_exp_f32 v63, v63
    v_cvt_pk_bf16_f32 v80, v60, v61
    v_exp_f32 v64, v64
    ds_read_b64 v[106:107], v125 offset:13904
    s_bitcmp1_b64 s[90:91], s61
    s_cbranch_scc1 F_OOL0
F_OOR0:
    v_mfma_f32_32x32x16_bf16 v[4:19], v[120:123], v[72:75], v[4:19]
    v_exp_f32 v65, v65
    v_cvt_pk_bf16_f32 v81, v62, v63
    v_exp_f32 v66, v66
    v_exp_f32 v67, v67
    v_cvt_pk_bf16_f32 v82, v64, v65
    v_cvt_pk_bf16_f32 v83, v66, v67
    v_mfma_f32_32x32x16_bf16 v[52:67], v[96:99], v[90:93], 0
    v_exp_f32 v36, v36
    v_exp_f32 v37, v37
    v_exp_f32 v38, v38
    v_exp_f32 v39, v39
    v_cvt_pk_bf16_f32 v68, v36, v37
    v_exp_f32 v40, v40
    ds_read_b64_tr_b16 v[108:109], v126 offset:10304
    ds_read_b64_tr_b16 v[110:111], v127 offset:10304
    v_mfma_f32_32x32x16_bf16 v[20:35], v[116:119], v[76:79], v[20:35]
    v_exp_f32 v41, v41
    v_cvt_pk_bf16_f32 v69, v38, v39
    v_exp_f32 v42, v42
    v_exp_f32 v43, v43
    v_cvt_pk_bf16_f32 v70, v40, v41
    v_exp_f32 v44, v44
    ds_read_b64_tr_b16 v[112:113], v128 offset:10304
    v_mfma_f32_32x32x8_bf16 v[52:67], v[100:101], v[94:95], v[52:67]
    v_exp_f32 v45, v45
    v_cvt_pk_bf16_f32 v71, v42, v43
    v_exp_f32 v46, v46
    v_exp_f32 v47, v47
    v_cvt_pk_bf16_f32 v72, v44, v45
    v_exp_f32 v48, v48
    ds_read_b64_tr_b16 v[114:115], v129 offset:10304
    v_mfma_f32_32x32x16_bf16 v[20:35], v[120:123], v[80:83], v[20:35]
    v_exp_f32 v49, v49
    v_cvt_pk_bf16_f32 v73, v46, v47
    v_exp_f32 v50, v50
    v_exp_f32 v51, v51
    v_cvt_pk_bf16_f32 v74, v48, v49
    v_cvt_pk_bf16_f32 v75, v50, v51
    s_waitcnt lgkmcnt(0)
    v_mfma_f32_32x32x16_bf16 v[36:51], v[102:105], v[84:87], 0
    v_exp_f32 v52, v52
    v_exp_f32 v53, v53
    v_exp_f32 v54, v54
    v_exp_f32 v55, v55
    v_cvt_pk_bf16_f32 v76, v52, v53
    v_exp_f32 v56, v56
    ds_read_b64 v[96:97], v124 offset:15456
    v_mfma_f32_32x32x16_bf16 v[4:19], v[108:111], v[68:71], v[4:19]
    v_exp_f32 v57, v57
    v_cvt_pk_bf16_f32 v77, v54, v55
    v_exp_f32 v58, v58
    v_exp_f32 v59, v59
    v_cvt_pk_bf16_f32 v78, v56, v57
    v_exp_f32 v60, v60
    ds_read_b64 v[98:99], v124 offset:15712
    v_mfma_f32_32x32x8_bf16 v[36:51], v[106:107], v[88:89], v[36:51]
    v_exp_f32 v61, v61
    v_cvt_pk_bf16_f32 v79, v58, v59
    v_exp_f32 v62, v62
    v_exp_f32 v63, v63
    v_cvt_pk_bf16_f32 v80, v60, v61
    v_exp_f32 v64, v64
    ds_read_b64 v[100:101], v125 offset:16480
    v_mfma_f32_32x32x16_bf16 v[4:19], v[112:115], v[72:75], v[4:19]
    v_exp_f32 v65, v65
    v_cvt_pk_bf16_f32 v81, v62, v63
    v_exp_f32 v66, v66
    v_exp_f32 v67, v67
    v_cvt_pk_bf16_f32 v82, v64, v65
    v_cvt_pk_bf16_f32 v83, v66, v67
    v_mfma_f32_32x32x16_bf16 v[52:67], v[102:105], v[90:93], 0
    v_exp_f32 v36, v36
    v_exp_f32 v37, v37
    v_exp_f32 v38, v38
    v_exp_f32 v39, v39
    v_cvt_pk_bf16_f32 v68, v36, v37
    v_exp_f32 v40, v40
    ds_read_b32 v139, v137
    ds_read_b32 v130, v131
    ds_read_b64_tr_b16 v[116:117], v126 offset:12880
    ds_read_b64_tr_b16 v[118:119], v127 offset:12880
    v_mfma_f32_32x32x16_bf16 v[20:35], v[108:111], v[76:79], v[20:35]
    v_exp_f32 v41, v41
    v_cvt_pk_bf16_f32 v69, v38, v39
    v_exp_f32 v42, v42
    v_exp_f32 v43, v43
    v_cvt_pk_bf16_f32 v70, v40, v41
    v_exp_f32 v44, v44
    ds_read_b64_tr_b16 v[120:121], v128 offset:12880
    v_mfma_f32_32x32x8_bf16 v[52:67], v[106:107], v[94:95], v[52:67]
    v_exp_f32 v45, v45
    v_cvt_pk_bf16_f32 v71, v42, v43
    v_exp_f32 v46, v46
    v_exp_f32 v47, v47
    v_cvt_pk_bf16_f32 v72, v44, v45
    v_exp_f32 v48, v48
    ds_read_b64_tr_b16 v[122:123], v129 offset:12880
    v_mfma_f32_32x32x16_bf16 v[20:35], v[112:115], v[80:83], v[20:35]
    v_exp_f32 v49, v49
    v_cvt_pk_bf16_f32 v73, v46, v47
    v_exp_f32 v50, v50
    v_exp_f32 v51, v51
    v_cvt_pk_bf16_f32 v74, v48, v49
    v_cvt_pk_bf16_f32 v75, v50, v51
    s_waitcnt lgkmcnt(0)
    v_mfma_f32_32x32x16_bf16 v[36:51], v[96:99], v[84:87], 0
    v_exp_f32 v52, v52
    v_readfirstlane_b32 s52, v139
    v_exp_f32 v53, v53
    v_readfirstlane_b32 s85, v130
    v_exp_f32 v54, v54
    v_exp_f32 v55, v55
    v_cvt_pk_bf16_f32 v76, v52, v53
    v_exp_f32 v56, v56
    s_cmp_ge_u32 s52, s61
    s_cbranch_scc0 PB_SPIN1
PB_SPUN1:
    ds_read_b64 v[102:103], v124 offset:18032
    v_mfma_f32_32x32x16_bf16 v[4:19], v[116:119], v[68:71], v[4:19]
    v_exp_f32 v57, v57
    v_cvt_pk_bf16_f32 v77, v54, v55
    v_exp_f32 v58, v58
    v_exp_f32 v59, v59
    v_cvt_pk_bf16_f32 v78, v56, v57
    v_exp_f32 v60, v60
    ds_read_b64 v[104:105], v124 offset:18288
    s_cmp_ge_u32 s61, 20
    s_cbranch_scc1 PB_NODMA1
    s_add_u32 m0, s62, 0
    s_nop 0
    buffer_load_dwordx4 v136, s[32:35], s60 offen sc1 lds
    buffer_load_dwordx4 v136, s[32:35], s60 offen offset:1024 sc1 lds
    buffer_load_dwordx4 v136, s[32:35], s60 offen offset:1536 sc1 lds
    s_add_u32 s60, s60, 10240
PB_DMAD1:
    v_mfma_f32_32x32x8_bf16 v[36:51], v[100:101], v[88:89], v[36:51]
    v_exp_f32 v61, v61
    v_cvt_pk_bf16_f32 v79, v58, v59
    v_exp_f32 v62, v62
    v_exp_f32 v63, v63
    v_cvt_pk_bf16_f32 v80, v60, v61
    v_exp_f32 v64, v64
    ds_read_b64 v[106:107], v125 offset:19056
    s_cmp_gt_u32 s85, s61
    s_setprio 0
    s_cbranch_scc0 PB_PR1
    s_setprio 1
PB_PR1:
    v_mfma_f32_32x32x16_bf16 v[4:19], v[120:123], v[72:75], v[4:19]
    v_exp_f32 v65, v65
    v_cvt_pk_bf16_f32 v81, v62, v63
    v_exp_f32 v66, v66
    v_exp_f32 v67, v67
    v_cvt_pk_bf16_f32 v82, v64, v65
    v_cvt_pk_bf16_f32 v83, v66, v67
    v_mfma_f32_32x32x16_bf16 v[52:67], v[96:99], v[90:93], 0
    v_exp_f32 v36, v36
    v_exp_f32 v37, v37
    v_exp_f32 v38, v38
    v_exp_f32 v39, v39
    v_cvt_pk_bf16_f32 v68, v36, v37
    v_exp_f32 v40, v40
    ds_read_b64_tr_b16 v[108:109], v126 offset:15456
    ds_read_b64_tr_b16 v[110:111], v127 offset:15456
    v_mfma_f32_32x32x16_bf16 v[20:35], v[116:119], v[76:79], v[20:35]
    v_exp_f32 v41, v41
    v_cvt_pk_bf16_f32 v69, v38, v39
    v_exp_f32 v42, v42
    v_exp_f32 v43, v43
    v_cvt_pk_bf16_f32 v70, v40, v41
    v_exp_f32 v44, v44
    ds_read_b64_tr_b16 v[112:113], v128 offset:15456
    v_mfma_f32_32x32x8_bf16 v[52:67], v[100:101], v[94:95], v[52:67]
    v_exp_f32 v45, v45
    v_cvt_pk_bf16_f32 v71, v42, v43
    v_exp_f32 v46, v46
    v_exp_f32 v47, v47
    v_cvt_pk_bf16_f32 v72, v44, v45
    v_exp_f32 v48, v48
    ds_read_b64_tr_b16 v[114:115], v129 offset:15456
    v_mfma_f32_32x32x16_bf16 v[20:35], v[120:123], v[80:83], v[20:35]
    v_exp_f32 v49, v49
    v_cvt_pk_bf16_f32 v73, v46, v47
    v_exp_f32 v50, v50
    v_exp_f32 v51, v51
    v_cvt_pk_bf16_f32 v74, v48, v49
    v_cvt_pk_bf16_f32 v75, v50, v51
    s_waitcnt lgkmcnt(0)
    v_mfma_f32_32x32x16_bf16 v[36:51], v[102:105], v[84:87], 0
    v_exp_f32 v52, v52
    v_exp_f32 v53, v53
    v_exp_f32 v54, v54
    v_exp_f32 v55, v55
    v_cvt_pk_bf16_f32 v76, v52, v53
    v_exp_f32 v56, v56
    ds_read_b64 v[96:97], v124 offset:20608
    v_mfma_f32_32x32x16_bf16 v[4:19], v[108:111], v[68:71], v[4:19]
    v_exp_f32 v57, v57
    v_cvt_pk_bf16_f32 v77, v54, v55
    v_exp_f32 v58, v58
    v_exp_f32 v59, v59
    v_cvt_pk_bf16_f32 v78, v56, v57
    v_exp_f32 v60, v60
    ds_read_b64 v[98:99], v124 offset:20864
    v_mfma_f32_32x32x8_bf16 v[36:51], v[106:107], v[88:89], v[36:51]
    v_exp_f32 v61, v61
    v_cvt_pk_bf16_f32 v79, v58, v59
    v_exp_f32 v62, v62
    v_exp_f32 v63, v63
    v_cvt_pk_bf16_f32 v80, v60, v61
    v_exp_f32 v64, v64
    ds_read_b64 v[100:101], v125 offset:21632
    v_mfma_f32_32x32x16_bf16 v[4:19], v[112:115], v[72:75], v[4:19]
    v_exp_f32 v65, v65
    v_cvt_pk_bf16_f32 v81, v62, v63
    v_exp_f32 v66, v66
    v_exp_f32 v67, v67
    v_cvt_pk_bf16_f32 v82, v64, v65
    v_cvt_pk_bf16_f32 v83, v66, v67
    v_mfma_f32_32x32x16_bf16 v[52:67], v[102:105], v[90:93], 0
    v_exp_f32 v36, v36
    v_exp_f32 v37, v37
    v_exp_f32 v38, v38
    v_exp_f32 v39, v39
    v_cvt_pk_bf16_f32 v68, v36, v37
    v_exp_f32 v40, v40
    ds_read_b64_tr_b16 v[116:117], v126 offset:18032
    ds_read_b64_tr_b16 v[118:119], v127 offset:18032
    v_mfma_f32_32x32x16_bf16 v[20:35], v[108:111], v[76:79], v[20:35]
    v_exp_f32 v41, v41
    v_cvt_pk_bf16_f32 v69, v38, v39
    v_exp_f32 v42, v42
    v_exp_f32 v43, v43
    v_cvt_pk_bf16_f32 v70, v40, v41
    v_exp_f32 v44, v44
    ds_read_b64_tr_b16 v[120:121], v128 offset:18032
    v_mfma_f32_32x32x8_bf16 v[52:67], v[106:107], v[94:95], v[52:67]
    v_exp_f32 v45, v45
    v_cvt_pk_bf16_f32 v71, v42, v43
    v_exp_f32 v46, v46
    v_exp_f32 v47, v47
    v_cvt_pk_bf16_f32 v72, v44, v45
    v_exp_f32 v48, v48
    ds_read_b64_tr_b16 v[122:123], v129 offset:18032
    v_mfma_f32_32x32x16_bf16 v[20:35], v[112:115], v[80:83], v[20:35]
    v_exp_f32 v49, v49
    v_cvt_pk_bf16_f32 v73, v46, v47
    v_exp_f32 v50, v50
    v_exp_f32 v51, v51
    v_cvt_pk_bf16_f32 v74, v48, v49
    v_cvt_pk_bf16_f32 v75, v50, v51
    s_waitcnt lgkmcnt(0)
    v_mfma_f32_32x32x16_bf16 v[36:51], v[96:99], v[84:87], 0
    v_exp_f32 v52, v52
    v_exp_f32 v53, v53
    v_exp_f32 v54, v54
    v_exp_f32 v55, v55
    v_cvt_pk_bf16_f32 v76, v52, v53
    v_exp_f32 v56, v56
    ds_read_b64 v[102:103], v124 offset:23184
    v_mfma_f32_32x32x16_bf16 v[4:19], v[116:119], v[68:71], v[4:19]
    v_exp_f32 v57, v57
    v_cvt_pk_bf16_f32 v77, v54, v55
    v_exp_f32 v58, v58
    v_exp_f32 v59, v59
    v_cvt_pk_bf16_f32 v78, v56, v57
    v_exp_f32 v60, v60
    ds_read_b64 v[104:105], v124 offset:23440
    s_waitcnt vmcnt(3)
    s_mov_b64 exec, 1
    ds_add_u32 v137, v138
    s_mov_b64 exec, -1
    s_add_u32 s61, s61, 4
    v_mfma_f32_32x32x8_bf16 v[36:51], v[100:101], v[88:89], v[36:51]
    v_exp_f32 v61, v61
    v_cvt_pk_bf16_f32 v79, v58, v59
    v_exp_f32 v62, v62
    v_exp_f32 v63, v63
    v_cvt_pk_bf16_f32 v80, v60, v61
    v_exp_f32 v64, v64
    ds_read_b64 v[106:107], v125 offset:24208
    s_bitcmp1_b64 s[90:91], s61
    s_cbranch_scc1 F_OOL1
F_OOR1:
    v_mfma_f32_32x32x16_bf16 v[4:19], v[120:123], v[72:75], v[4:19]
    v_exp_f32 v65, v65
    v_cvt_pk_bf16_f32 v81, v62, v63
    v_exp_f32 v66, v66
    v_exp_f32 v67, v67
    v_cvt_pk_bf16_f32 v82, v64, v65
    v_cvt_pk_bf16_f32 v83, v66, v67
    v_mfma_f32_32x32x16_bf16 v[52:67], v[96:99], v[90:93], 0
    v_exp_f32 v36, v36
    v_exp_f32 v37, v37
    v_exp_f32 v38, v38
    v_exp_f32 v39, v39
    v_cvt_pk_bf16_f32 v68, v36, v37
    v_exp_f32 v40, v40
    ds_read_b64_tr_b16 v[108:109], v126 offset:20608
    ds_read_b64_tr_b16 v[110:111], v127 offset:20608
    v_mfma_f32_32x32x16_bf16 v[20:35], v[116:119], v[76:79], v[20:35]
    v_exp_f32 v41, v41
    v_cvt_pk_bf16_f32 v69, v38, v39
    v_exp_f32 v42, v42
    v_exp_f32 v43, v43
    v_cvt_pk_bf16_f32 v70, v40, v41
    v_exp_f32 v44, v44
    ds_read_b64_tr_b16 v[112:113], v128 offset:20608
    v_mfma_f32_32x32x8_bf16 v[52:67], v[100:101], v[94:95], v[52:67]
    v_exp_f32 v45, v45
    v_cvt_pk_bf16_f32 v71, v42, v43
    v_exp_f32 v46, v46
    v_exp_f32 v47, v47
    v_cvt_pk_bf16_f32 v72, v44, v45
    v_exp_f32 v48, v48
    ds_read_b64_tr_b16 v[114:115], v129 offset:20608
    v_mfma_f32_32x32x16_bf16 v[20:35], v[120:123], v[80:83], v[20:35]
    v_exp_f32 v49, v49
    v_cvt_pk_bf16_f32 v73, v46, v47
    v_exp_f32 v50, v50
    v_exp_f32 v51, v51
    v_cvt_pk_bf16_f32 v74, v48, v49
    v_cvt_pk_bf16_f32 v75, v50, v51
    s_waitcnt lgkmcnt(0)
    v_mfma_f32_32x32x16_bf16 v[36:51], v[102:105], v[84:87], 0
    v_exp_f32 v52, v52
    v_exp_f32 v53, v53
    v_exp_f32 v54, v54
    v_exp_f32 v55, v55
    v_cvt_pk_bf16_f32 v76, v52, v53
    v_exp_f32 v56, v56
    ds_read_b64 v[96:97], v124 offset:25760
    v_mfma_f32_32x32x16_bf16 v[4:19], v[108:111], v[68:71], v[4:19]
    v_exp_f32 v57, v57
    v_cvt_pk_bf16_f32 v77, v54, v55
    v_exp_f32 v58, v58
    v_exp_f32 v59, v59
    v_cvt_pk_bf16_f32 v78, v56, v57
    v_exp_f32 v60, v60
    ds_read_b64 v[98:99], v124 offset:26016
    v_mfma_f32_32x32x8_bf16 v[36:51], v[106:107], v[88:89], v[36:51]
    v_exp_f32 v61, v61
    v_cvt_pk_bf16_f32 v79, v58, v59
    v_exp_f32 v62, v62
    v_exp_f32 v63, v63
    v_cvt_pk_bf16_f32 v80, v60, v61
    v_exp_f32 v64, v64
    ds_read_b64 v[100:101], v125 offset:26784
    v_mfma_f32_32x32x16_bf16 v[4:19], v[112:115], v[72:75], v[4:19]
    v_exp_f32 v65, v65
    v_cvt_pk_bf16_f32 v81, v62, v63
    v_exp_f32 v66, v66
    v_exp_f32 v67, v67
    v_cvt_pk_bf16_f32 v82, v64, v65
    v_cvt_pk_bf16_f32 v83, v66, v67
    v_mfma_f32_32x32x16_bf16 v[52:67], v[102:105], v[90:93], 0
    v_exp_f32 v36, v36
    v_exp_f32 v37, v37
    v_exp_f32 v38, v38
    v_exp_f32 v39, v39
    v_cvt_pk_bf16_f32 v68, v36, v37
    v_exp_f32 v40, v40
    ds_read_b32 v139, v137
    ds_read_b32 v130, v131
    ds_read_b64_tr_b16 v[116:117], v126 offset:23184
    ds_read_b64_tr_b16 v[118:119], v127 offset:23184
    v_mfma_f32_32x32x16_bf16 v[20:35], v[108:111], v[76:79], v[20:35]
    v_exp_f32 v41, v41
    v_cvt_pk_bf16_f32 v69, v38, v39
    v_exp_f32 v42, v42
    v_exp_f32 v43, v43
    v_cvt_pk_bf16_f32 v70, v40, v41
    v_exp_f32 v44, v44
    ds_read_b64_tr_b16 v[120:121], v128 offset:23184
    v_mfma_f32_32x32x8_bf16 v[52:67], v[106:107], v[94:95], v[52:67]
    v_exp_f32 v45, v45
    v_cvt_pk_bf16_f32 v71, v42, v43
    v_exp_f32 v46, v46
    v_exp_f32 v47, v47
    v_cvt_pk_bf16_f32 v72, v44, v45
    v_exp_f32 v48, v48
    ds_read_b64_tr_b16 v[122:123], v129 offset:23184
    v_mfma_f32_32x32x16_bf16 v[20:35], v[112:115], v[80:83], v[20:35]
    v_exp_f32 v49, v49
    v_cvt_pk_bf16_f32 v73, v46, v47
    v_exp_f32 v50, v50
    v_exp_f32 v51, v51
    v_cvt_pk_bf16_f32 v74, v48, v49
    v_cvt_pk_bf16_f32 v75, v50, v51
    s_waitcnt lgkmcnt(0)
    v_mfma_f32_32x32x16_bf16 v[36:51], v[96:99], v[84:87], 0
    v_exp_f32 v52, v52
    v_readfirstlane_b32 s52, v139
    v_exp_f32 v53, v53
    v_readfirstlane_b32 s85, v130
    v_exp_f32 v54, v54
    v_exp_f32 v55, v55
    v_cvt_pk_bf16_f32 v76, v52, v53
    v_exp_f32 v56, v56
    s_cmp_ge_u32 s52, s61
    s_cbranch_scc0 PB_SPIN2
PB_SPUN2:
    ds_read_b64 v[102:103], v124 offset:28336
    v_mfma_f32_32x32x16_bf16 v[4:19], v[116:119], v[68:71], v[4:19]
    v_exp_f32 v57, v57
    v_cvt_pk_bf16_f32 v77, v54, v55
    v_exp_f32 v58, v58
    v_exp_f32 v59, v59
    v_cvt_pk_bf16_f32 v78, v56, v57
    v_exp_f32 v60, v60
    ds_read_b64 v[104:105], v124 offset:28592
    s_cmp_ge_u32 s61, 20
    s_cbranch_scc1 PB_NODMA2
    s_add_u32 m0, s62, 10304
    s_nop 0
    buffer_load_dwordx4 v136, s[32:35], s60 offen sc1 lds
    buffer_load_dwordx4 v136, s[32:35], s60 offen offset:1024 sc1 lds
    buffer_load_dwordx4 v136, s[32:35], s60 offen offset:1536 sc1 lds
    s_add_u32 s60, s60, 10240
PB_DMAD2:
    v_mfma_f32_32x32x8_bf16 v[36:51], v[100:101], v[88:89], v[36:51]
    v_exp_f32 v61, v61
    v_cvt_pk_bf16_f32 v79, v58, v59
    v_exp_f32 v62, v62
    v_exp_f32 v63, v63
    v_cvt_pk_bf16_f32 v80, v60, v61
    v_exp_f32 v64, v64
    ds_read_b64 v[106:107], v125 offset:29360
    s_cmp_gt_u32 s85, s61
    s_setprio 0
    s_cbranch_scc0 PB_PR2
    s_setprio 1
PB_PR2:
    v_mfma_f32_32x32x16_bf16 v[4:19], v[120:123], v[72:75], v[4:19]
    v_exp_f32 v65, v65
    v_cvt_pk_bf16_f32 v81, v62, v63
    v_exp_f32 v66, v66
    v_exp_f32 v67, v67
    v_cvt_pk_bf16_f32 v82, v64, v65
    v_cvt_pk_bf16_f32 v83, v66, v67
    v_mfma_f32_32x32x16_bf16 v[52:67], v[96:99], v[90:93], 0
    v_exp_f32 v36, v36
    v_exp_f32 v37, v37
    v_exp_f32 v38, v38
    v_exp_f32 v39, v39
    v_cvt_pk_bf16_f32 v68, v36, v37
    v_exp_f32 v40, v40
    ds_read_b64_tr_b16 v[108:109], v126 offset:25760
    ds_read_b64_tr_b16 v[110:111], v127 offset:25760
    v_mfma_f32_32x32x16_bf16 v[20:35], v[116:119], v[76:79], v[20:35]
    v_exp_f32 v41, v41
    v_cvt_pk_bf16_f32 v69, v38, v39
    v_exp_f32 v42, v42
    v_exp_f32 v43, v43
    v_cvt_pk_bf16_f32 v70, v40, v41
    v_exp_f32 v44, v44
    ds_read_b64_tr_b16 v[112:113], v128 offset:25760
    v_mfma_f32_32x32x8_bf16 v[52:67], v[100:101], v[94:95], v[52:67]
    v_exp_f32 v45, v45
    v_cvt_pk_bf16_f32 v71, v42, v43
    v_exp_f32 v46, v46
    v_exp_f32 v47, v47
    v_cvt_pk_bf16_f32 v72, v44, v45
    v_exp_f32 v48, v48
    ds_read_b64_tr_b16 v[114:115], v129 offset:25760
    v_mfma_f32_32x32x16_bf16 v[20:35], v[120:123], v[80:83], v[20:35]
    v_exp_f32 v49, v49
    v_cvt_pk_bf16_f32 v73, v46, v47
    v_exp_f32 v50, v50
    v_exp_f32 v51, v51
    v_cvt_pk_bf16_f32 v74, v48, v49
    v_cvt_pk_bf16_f32 v75, v50, v51
    s_waitcnt lgkmcnt(0)
    v_mfma_f32_32x32x16_bf16 v[36:51], v[102:105], v[84:87], 0
    v_exp_f32 v52, v52
    v_exp_f32 v53, v53
    v_exp_f32 v54, v54
    v_exp_f32 v55, v55
    v_cvt_pk_bf16_f32 v76, v52, v53
    v_exp_f32 v56, v56
    ds_read_b64 v[96:97], v124 offset:30912
    v_mfma_f32_32x32x16_bf16 v[4:19], v[108:111], v[68:71], v[4:19]
    v_exp_f32 v57, v57
    v_cvt_pk_bf16_f32 v77, v54, v55
    v_exp_f32 v58, v58
    v_exp_f32 v59, v59
    v_cvt_pk_bf16_f32 v78, v56, v57
    v_exp_f32 v60, v60
    ds_read_b64 v[98:99], v124 offset:31168
    v_mfma_f32_32x32x8_bf16 v[36:51], v[106:107], v[88:89], v[36:51]
    v_exp_f32 v61, v61
    v_cvt_pk_bf16_f32 v79, v58, v59
    v_exp_f32 v62, v62
    v_exp_f32 v63, v63
    v_cvt_pk_bf16_f32 v80, v60, v61
    v_exp_f32 v64, v64
    ds_read_b64 v[100:101], v125 offset:31936
    v_mfma_f32_32x32x16_bf16 v[4:19], v[112:115], v[72:75], v[4:19]
    v_exp_f32 v65, v65
    v_cvt_pk_bf16_f32 v81, v62, v63
    v_exp_f32 v66, v66
    v_exp_f32 v67, v67
    v_cvt_pk_bf16_f32 v82, v64, v65
    v_cvt_pk_bf16_f32 v83, v66, v67
    v_mfma_f32_32x32x16_bf16 v[52:67], v[102:105], v[90:93], 0
    v_exp_f32 v36, v36
    v_exp_f32 v37, v37
    v_exp_f32 v38, v38
    v_exp_f32 v39, v39
    v_cvt_pk_bf16_f32 v68, v36, v37
    v_exp_f32 v40, v40
    ds_read_b64_tr_b16 v[116:117], v126 offset:28336
    ds_read_b64_tr_b16 v[118:119], v127 offset:28336
    v_mfma_f32_32x32x16_bf16 v[20:35], v[108:111], v[76:79], v[20:35]
    v_exp_f32 v41, v41
    v_cvt_pk_bf16_f32 v69, v38, v39
    v_exp_f32 v42, v42
    v_exp_f32 v43, v43
    v_cvt_pk_bf16_f32 v70, v40, v41
    v_exp_f32 v44, v44
    ds_read_b64_tr_b16 v[120:121], v128 offset:28336
    v_mfma_f32_32x32x8_bf16 v[52:67], v[106:107], v[94:95], v[52:67]
    v_exp_f32 v45, v45
    v_cvt_pk_bf16_f32 v71, v42, v43
    v_exp_f32 v46, v46
    v_exp_f32 v47, v47
    v_cvt_pk_bf16_f32 v72, v44, v45
    v_exp_f32 v48, v48
    ds_read_b64_tr_b16 v[122:123], v129 offset:28336
    v_mfma_f32_32x32x16_bf16 v[20:35], v[112:115], v[80:83], v[20:35]
    v_exp_f32 v49, v49
    v_cvt_pk_bf16_f32 v73, v46, v47
    v_exp_f32 v50, v50
    v_exp_f32 v51, v51
    v_cvt_pk_bf16_f32 v74, v48, v49
    v_cvt_pk_bf16_f32 v75, v50, v51
    s_waitcnt lgkmcnt(0)
    v_mfma_f32_32x32x16_bf16 v[36:51], v[96:99], v[84:87], 0
    v_exp_f32 v52, v52
    v_exp_f32 v53, v53
    v_exp_f32 v54, v54
    v_exp_f32 v55, v55
    v_cvt_pk_bf16_f32 v76, v52, v53
    v_exp_f32 v56, v56
    ds_read_b64 v[102:103], v124 offset:33488
    v_mfma_f32_32x32x16_bf16 v[4:19], v[116:119], v[68:71], v[4:19]
    v_exp_f32 v57, v57
    v_cvt_pk_bf16_f32 v77, v54, v55
    v_exp_f32 v58, v58
    v_exp_f32 v59, v59
    v_cvt_pk_bf16_f32 v78, v56, v57
    v_exp_f32 v60, v60
    ds_read_b64 v[104:105], v124 offset:33744
    s_waitcnt vmcnt(3)
    s_mov_b64 exec, 1
    ds_add_u32 v137, v138
    s_mov_b64 exec, -1
    s_add_u32 s61, s61, 4
    v_mfma_f32_32x32x8_bf16 v[36:51], v[100:101], v[88:89], v[36:51]
    v_exp_f32 v61, v61
    v_cvt_pk_bf16_f32 v79, v58, v59
    v_exp_f32 v62, v62
    v_exp_f32 v63, v63
    v_cvt_pk_bf16_f32 v80, v60, v61
    v_exp_f32 v64, v64
    ds_read_b64 v[106:107], v125 offset:34512
    s_bitcmp1_b64 s[90:91], s61
    s_cbranch_scc1 F_OOL2
F_OOR2:
    v_mfma_f32_32x32x16_bf16 v[4:19], v[120:123], v[72:75], v[4:19]
    v_exp_f32 v65, v65
    v_cvt_pk_bf16_f32 v81, v62, v63
    v_exp_f32 v66, v66
    v_exp_f32 v67, v67
    v_cvt_pk_bf16_f32 v82, v64, v65
    v_cvt_pk_bf16_f32 v83, v66, v67
    v_mfma_f32_32x32x16_bf16 v[52:67], v[96:99], v[90:93], 0
    v_exp_f32 v36, v36
    v_exp_f32 v37, v37
    v_exp_f32 v38, v38
    v_exp_f32 v39, v39
    v_cvt_pk_bf16_f32 v68, v36, v37
    v_exp_f32 v40, v40
    ds_read_b64_tr_b16 v[108:109], v126 offset:30912
    ds_read_b64_tr_b16 v[110:111], v127 offset:30912
    v_mfma_f32_32x32x16_bf16 v[20:35], v[116:119], v[76:79], v[20:35]
    v_exp_f32 v41, v41
    v_cvt_pk_bf16_f32 v69, v38, v39
    v_exp_f32 v42, v42
    v_exp_f32 v43, v43
    v_cvt_pk_bf16_f32 v70, v40, v41
    v_exp_f32 v44, v44
    ds_read_b64_tr_b16 v[112:113], v128 offset:30912
    v_mfma_f32_32x32x8_bf16 v[52:67], v[100:101], v[94:95], v[52:67]
    v_exp_f32 v45, v45
    v_cvt_pk_bf16_f32 v71, v42, v43
    v_exp_f32 v46, v46
    v_exp_f32 v47, v47
    v_cvt_pk_bf16_f32 v72, v44, v45
    v_exp_f32 v48, v48
    ds_read_b64_tr_b16 v[114:115], v129 offset:30912
    v_mfma_f32_32x32x16_bf16 v[20:35], v[120:123], v[80:83], v[20:35]
    v_exp_f32 v49, v49
    v_cvt_pk_bf16_f32 v73, v46, v47
    v_exp_f32 v50, v50
    v_exp_f32 v51, v51
    v_cvt_pk_bf16_f32 v74, v48, v49
    v_cvt_pk_bf16_f32 v75, v50, v51
    s_waitcnt lgkmcnt(0)
    v_mfma_f32_32x32x16_bf16 v[36:51], v[102:105], v[84:87], 0
    v_exp_f32 v52, v52
    v_exp_f32 v53, v53
    v_exp_f32 v54, v54
    v_exp_f32 v55, v55
    v_cvt_pk_bf16_f32 v76, v52, v53
    v_exp_f32 v56, v56
    ds_read_b64 v[96:97], v124 offset:36064
    v_mfma_f32_32x32x16_bf16 v[4:19], v[108:111], v[68:71], v[4:19]
    v_exp_f32 v57, v57
    v_cvt_pk_bf16_f32 v77, v54, v55
    v_exp_f32 v58, v58
    v_exp_f32 v59, v59
    v_cvt_pk_bf16_f32 v78, v56, v57
    v_exp_f32 v60, v60
    ds_read_b64 v[98:99], v124 offset:36320
    v_mfma_f32_32x32x8_bf16 v[36:51], v[106:107], v[88:89], v[36:51]
    v_exp_f32 v61, v61
    v_cvt_pk_bf16_f32 v79, v58, v59
    v_exp_f32 v62, v62
    v_exp_f32 v63, v63
    v_cvt_pk_bf16_f32 v80, v60, v61
    v_exp_f32 v64, v64
    ds_read_b64 v[100:101], v125 offset:37088
    v_mfma_f32_32x32x16_bf16 v[4:19], v[112:115], v[72:75], v[4:19]
    v_exp_f32 v65, v65
    v_cvt_pk_bf16_f32 v81, v62, v63
    v_exp_f32 v66, v66
    v_exp_f32 v67, v67
    v_cvt_pk_bf16_f32 v82, v64, v65
    v_cvt_pk_bf16_f32 v83, v66, v67
    v_mfma_f32_32x32x16_bf16 v[52:67], v[102:105], v[90:93], 0
    v_exp_f32 v36, v36
    v_exp_f32 v37, v37
    v_exp_f32 v38, v38
    v_exp_f32 v39, v39
    v_cvt_pk_bf16_f32 v68, v36, v37
    v_exp_f32 v40, v40
    ds_read_b32 v139, v137
    ds_read_b32 v130, v131
    ds_read_b64_tr_b16 v[116:117], v126 offset:33488
    ds_read_b64_tr_b16 v[118:119], v127 offset:33488
    v_mfma_f32_32x32x16_bf16 v[20:35], v[108:111], v[76:79], v[20:35]
    v_exp_f32 v41, v41
    v_cvt_pk_bf16_f32 v69, v38, v39
    v_exp_f32 v42, v42
    v_exp_f32 v43, v43
    v_cvt_pk_bf16_f32 v70, v40, v41
    v_exp_f32 v44, v44
    ds_read_b64_tr_b16 v[120:121], v128 offset:33488
    v_mfma_f32_32x32x8_bf16 v[52:67], v[106:107], v[94:95], v[52:67]
    v_exp_f32 v45, v45
    v_cvt_pk_bf16_f32 v71, v42, v43
    v_exp_f32 v46, v46
    v_exp_f32 v47, v47
    v_cvt_pk_bf16_f32 v72, v44, v45
    v_exp_f32 v48, v48
    ds_read_b64_tr_b16 v[122:123], v129 offset:33488
    v_mfma_f32_32x32x16_bf16 v[20:35], v[112:115], v[80:83], v[20:35]
    v_exp_f32 v49, v49
    v_cvt_pk_bf16_f32 v73, v46, v47
    v_exp_f32 v50, v50
    v_exp_f32 v51, v51
    v_cvt_pk_bf16_f32 v74, v48, v49
    v_cvt_pk_bf16_f32 v75, v50, v51
    s_waitcnt lgkmcnt(0)
    v_mfma_f32_32x32x16_bf16 v[36:51], v[96:99], v[84:87], 0
    v_exp_f32 v52, v52
    v_readfirstlane_b32 s52, v139
    v_exp_f32 v53, v53
    v_readfirstlane_b32 s85, v130
    v_exp_f32 v54, v54
    v_exp_f32 v55, v55
    v_cvt_pk_bf16_f32 v76, v52, v53
    v_exp_f32 v56, v56
    s_cmp_ge_u32 s52, s61
    s_cbranch_scc0 PB_SPIN3
PB_SPUN3:
    ds_read_b64 v[102:103], v124 offset:38640
    v_mfma_f32_32x32x16_bf16 v[4:19], v[116:119], v[68:71], v[4:19]
    v_exp_f32 v57, v57
    v_cvt_pk_bf16_f32 v77, v54, v55
    v_exp_f32 v58, v58
    v_exp_f32 v59, v59
    v_cvt_pk_bf16_f32 v78, v56, v57
    v_exp_f32 v60, v60
    ds_read_b64 v[104:105], v124 offset:38896
    s_cmp_ge_u32 s61, 20
    s_cbranch_scc1 PB_NODMA3
    s_add_u32 m0, s62, 20608
    s_nop 0
    buffer_load_dwordx4 v136, s[32:35], s60 offen sc1 lds
    buffer_load_dwordx4 v136, s[32:35], s60 offen offset:1024 sc1 lds
    buffer_load_dwordx4 v136, s[32:35], s60 offen offset:1536 sc1 lds
    s_add_u32 s60, s60, 10240
PB_DMAD3:
    v_mfma_f32_32x32x8_bf16 v[36:51], v[100:101], v[88:89], v[36:51]
    v_exp_f32 v61, v61
    v_cvt_pk_bf16_f32 v79, v58, v59
    v_exp_f32 v62, v62
    v_exp_f32 v63, v63
    v_cvt_pk_bf16_f32 v80, v60, v61
    v_exp_f32 v64, v64
    ds_read_b64 v[106:107], v125 offset:39664
    s_cmp_gt_u32 s85, s61
    s_setprio 0
    s_cbranch_scc0 PB_PR3
    s_setprio 1
PB_PR3:
    v_mfma_f32_32x32x16_bf16 v[4:19], v[120:123], v[72:75], v[4:19]
    v_exp_f32 v65, v65
    v_cvt_pk_bf16_f32 v81, v62, v63
    v_exp_f32 v66, v66
    v_exp_f32 v67, v67
    v_cvt_pk_bf16_f32 v82, v64, v65
    v_cvt_pk_bf16_f32 v83, v66, v67
    v_mfma_f32_32x32x16_bf16 v[52:67], v[96:99], v[90:93], 0
    v_exp_f32 v36, v36
    v_exp_f32 v37, v37
    v_exp_f32 v38, v38
    v_exp_f32 v39, v39
    v_cvt_pk_bf16_f32 v68, v36, v37
    v_exp_f32 v40, v40
    ds_read_b64_tr_b16 v[108:109], v126 offset:36064
    ds_read_b64_tr_b16 v[110:111], v127 offset:36064
    v_mfma_f32_32x32x16_bf16 v[20:35], v[116:119], v[76:79], v[20:35]
    v_exp_f32 v41, v41
    v_cvt_pk_bf16_f32 v69, v38, v39
    v_exp_f32 v42, v42
    v_exp_f32 v43, v43
    v_cvt_pk_bf16_f32 v70, v40, v41
    v_exp_f32 v44, v44
    ds_read_b64_tr_b16 v[112:113], v128 offset:36064
    v_mfma_f32_32x32x8_bf16 v[52:67], v[100:101], v[94:95], v[52:67]
    v_exp_f32 v45, v45
    v_cvt_pk_bf16_f32 v71, v42, v43
    v_exp_f32 v46, v46
    v_exp_f32 v47, v47
    v_cvt_pk_bf16_f32 v72, v44, v45
    v_exp_f32 v48, v48
    ds_read_b64_tr_b16 v[114:115], v129 offset:36064
    v_mfma_f32_32x32x16_bf16 v[20:35], v[120:123], v[80:83], v[20:35]
    v_exp_f32 v49, v49
    v_cvt_pk_bf16_f32 v73, v46, v47
    v_exp_f32 v50, v50
    v_exp_f32 v51, v51
    v_cvt_pk_bf16_f32 v74, v48, v49
    v_cvt_pk_bf16_f32 v75, v50, v51
    s_waitcnt lgkmcnt(0)
    v_mfma_f32_32x32x16_bf16 v[36:51], v[102:105], v[84:87], 0
    v_exp_f32 v52, v52
    v_exp_f32 v53, v53
    v_exp_f32 v54, v54
    v_exp_f32 v55, v55
    v_cvt_pk_bf16_f32 v76, v52, v53
    v_exp_f32 v56, v56
    ds_read_b64 v[96:97], v124 offset:0
    v_mfma_f32_32x32x16_bf16 v[4:19], v[108:111], v[68:71], v[4:19]
    v_exp_f32 v57, v57
    v_cvt_pk_bf16_f32 v77, v54, v55
    v_exp_f32 v58, v58
    v_exp_f32 v59, v59
    v_cvt_pk_bf16_f32 v78, v56, v57
    v_exp_f32 v60, v60
    ds_read_b64 v[98:99], v124 offset:256
    v_mfma_f32_32x32x8_bf16 v[36:51], v[106:107], v[88:89], v[36:51]
    v_exp_f32 v61, v61
    v_cvt_pk_bf16_f32 v79, v58, v59
    v_exp_f32 v62, v62
    v_exp_f32 v63, v63
    v_cvt_pk_bf16_f32 v80, v60, v61
    v_exp_f32 v64, v64
    ds_read_b64 v[100:101], v125 offset:1024
    v_mfma_f32_32x32x16_bf16 v[4:19], v[112:115], v[72:75], v[4:19]
    v_exp_f32 v65, v65
    v_cvt_pk_bf16_f32 v81, v62, v63
    v_exp_f32 v66, v66
    v_exp_f32 v67, v67
    v_cvt_pk_bf16_f32 v82, v64, v65
    v_cvt_pk_bf16_f32 v83, v66, v67
    v_mfma_f32_32x32x16_bf16 v[52:67], v[102:105], v[90:93], 0
    v_exp_f32 v36, v36
    v_exp_f32 v37, v37
    v_exp_f32 v38, v38
    v_exp_f32 v39, v39
    v_cvt_pk_bf16_f32 v68, v36, v37
    v_exp_f32 v40, v40
    ds_read_b64_tr_b16 v[116:117], v126 offset:38640
    ds_read_b64_tr_b16 v[118:119], v127 offset:38640
    v_mfma_f32_32x32x16_bf16 v[20:35], v[108:111], v[76:79], v[20:35]
    v_exp_f32 v41, v41
    v_cvt_pk_bf16_f32 v69, v38, v39
    v_exp_f32 v42, v42
    v_exp_f32 v43, v43
    v_cvt_pk_bf16_f32 v70, v40, v41
    v_exp_f32 v44, v44
    ds_read_b64_tr_b16 v[120:121], v128 offset:38640
    v_mfma_f32_32x32x8_bf16 v[52:67], v[106:107], v[94:95], v[52:67]
    v_exp_f32 v45, v45
    v_cvt_pk_bf16_f32 v71, v42, v43
    v_exp_f32 v46, v46
    v_exp_f32 v47, v47
    v_cvt_pk_bf16_f32 v72, v44, v45
    v_exp_f32 v48, v48
    ds_read_b64_tr_b16 v[122:123], v129 offset:38640
    v_mfma_f32_32x32x16_bf16 v[20:35], v[112:115], v[80:83], v[20:35]
    v_exp_f32 v49, v49
    v_cvt_pk_bf16_f32 v73, v46, v47
    v_exp_f32 v50, v50
    v_exp_f32 v51, v51
    v_cvt_pk_bf16_f32 v74, v48, v49
    v_cvt_pk_bf16_f32 v75, v50, v51
    s_waitcnt lgkmcnt(0)
    v_mfma_f32_32x32x16_bf16 v[36:51], v[96:99], v[84:87], 0
    v_exp_f32 v52, v52
    v_exp_f32 v53, v53
    v_exp_f32 v54, v54
    v_exp_f32 v55, v55
    v_cvt_pk_bf16_f32 v76, v52, v53
    v_exp_f32 v56, v56
    ds_read_b64 v[102:103], v124 offset:2576
    v_mfma_f32_32x32x16_bf16 v[4:19], v[116:119], v[68:71], v[4:19]
    v_exp_f32 v57, v57
    v_cvt_pk_bf16_f32 v77, v54, v55
    v_exp_f32 v58, v58
    v_exp_f32 v59, v59
    v_cvt_pk_bf16_f32 v78, v56, v57
    v_exp_f32 v60, v60
    ds_read_b64 v[104:105], v124 offset:2832
    s_waitcnt vmcnt(3)
    s_mov_b64 exec, 1
    ds_add_u32 v137, v138
    s_mov_b64 exec, -1
    s_add_u32 s61, s61, 4
    v_mfma_f32_32x32x8_bf16 v[36:51], v[100:101], v[88:89], v[36:51]
    v_exp_f32 v61, v61
    v_cvt_pk_bf16_f32 v79, v58, v59
    v_exp_f32 v62, v62
    v_exp_f32 v63, v63
    v_cvt_pk_bf16_f32 v80, v60, v61
    v_exp_f32 v64, v64
    ds_read_b64 v[106:107], v125 offset:3600
    s_bitcmp1_b64 s[90:91], s61
    s_cbranch_scc1 F_OOL3
F_OOR3:
    v_mfma_f32_32x32x16_bf16 v[4:19], v[120:123], v[72:75], v[4:19]
    v_exp_f32 v65, v65
    v_cvt_pk_bf16_f32 v81, v62, v63
    v_exp_f32 v66, v66
    v_exp_f32 v67, v67
    v_cvt_pk_bf16_f32 v82, v64, v65
    s_cmp_lt_u32 s61, 32
    v_cvt_pk_bf16_f32 v83, v66, v67
    s_cbranch_scc1 PB_LOOP
    v_mfma_f32_32x32x16_bf16 v[20:35], v[116:119], v[76:79], v[20:35]
    v_mfma_f32_32x32x16_bf16 v[20:35], v[120:123], v[80:83], v[20:35]
PB_COMBINE:
    s_setprio 0
    s_lshr_b32 s52, s83, 1
    s_mul_i32 s52, s52, 10304
    s_add_u32 s52, s52, 10304
    s_and_b32 s53, s83, 1
    s_lshl_b32 s53, s53, 12
    s_add_u32 s52, s52, s53
    s_sub_u32 s53, 41216, s58
    s_add_u32 s53, s53, s52
    s_add_u32 s52, s52, s58
    v_add_u32 v140, s52, v136
    v_add_u32 v141, s53, v136
    s_cmp_eq_u32 s82, 0
    s_cbranch_scc0 PB_G1
    ds_write_b128 v140, v[20:23] offset:0
    ds_write_b128 v140, v[24:27] offset:1024
    ds_write_b128 v140, v[28:31] offset:2048
    ds_write_b32 v140, v32 offset:3072
    s_waitcnt lgkmcnt(0)
    s_barrier
    ds_read_b32 v64, v141 offset:3072
    ds_read_b128 v[52:55], v141 offset:0
    ds_read_b128 v[56:59], v141 offset:1024
    ds_read_b128 v[60:63], v141 offset:2048
    s_waitcnt lgkmcnt(3)
    v_add_f32 v48, v16, v64
    v_rcp_f32 v142, v48
    s_waitcnt lgkmcnt(2)
    v_pk_add_f32 v[36:37], v[4:5], v[52:53]
    v_pk_add_f32 v[38:39], v[6:7], v[54:55]
    s_waitcnt lgkmcnt(1)
    v_pk_add_f32 v[40:41], v[8:9], v[56:57]
    v_pk_add_f32 v[42:43], v[10:11], v[58:59]
    s_waitcnt lgkmcnt(0)
    v_pk_add_f32 v[44:45], v[12:13], v[60:61]
    v_pk_add_f32 v[46:47], v[14:15], v[62:63]
    s_branch PB_FIN
PB_G1:
    ds_write_b128 v140, v[4:7] offset:0
    ds_write_b128 v140, v[8:11] offset:1024
    ds_write_b128 v140, v[12:15] offset:2048
    ds_write_b32 v140, v16 offset:3072
    s_waitcnt lgkmcnt(0)
    s_barrier
    ds_read_b32 v64, v141 offset:3072
    ds_read_b128 v[52:55], v141 offset:0
    ds_read_b128 v[56:59], v141 offset:1024
    ds_read_b128 v[60:63], v141 offset:2048
    s_waitcnt lgkmcnt(3)
    v_add_f32 v48, v32, v64
    v_rcp_f32 v142, v48
    s_waitcnt lgkmcnt(2)
    v_pk_add_f32 v[36:37], v[20:21], v[52:53]
    v_pk_add_f32 v[38:39], v[22:23], v[54:55]
    s_waitcnt lgkmcnt(1)
    v_pk_add_f32 v[40:41], v[24:25], v[56:57]
    v_pk_add_f32 v[42:43], v[26:27], v[58:59]
    s_waitcnt lgkmcnt(0)
    v_pk_add_f32 v[44:45], v[28:29], v[60:61]
    v_pk_add_f32 v[46:47], v[30:31], v[62:63]
PB_FIN:
    v_pk_mul_f32 v[52:53], v[36:37], 0 op_sel_hi:[1,0]
    v_pk_fma_f32 v[52:53], v[38:39], 0, v[52:53] op_sel_hi:[1,0,1]
    v_pk_fma_f32 v[52:53], v[40:41], 0, v[52:53] op_sel_hi:[1,0,1]
    v_pk_fma_f32 v[52:53], v[42:43], 0, v[52:53] op_sel_hi:[1,0,1]
    v_pk_fma_f32 v[52:53], v[44:45], 0, v[52:53] op_sel_hi:[1,0,1]
    v_pk_fma_f32 v[52:53], v[46:47], 0, v[52:53] op_sel_hi:[1,0,1]
    v_pk_mul_f32 v[36:37], v[36:37], v[142:143] op_sel_hi:[1,0]
    v_pk_mul_f32 v[38:39], v[38:39], v[142:143] op_sel_hi:[1,0]
    v_pk_mul_f32 v[40:41], v[40:41], v[142:143] op_sel_hi:[1,0]
    v_pk_mul_f32 v[42:43], v[42:43], v[142:143] op_sel_hi:[1,0]
    v_pk_mul_f32 v[44:45], v[44:45], v[142:143] op_sel_hi:[1,0]
    v_pk_mul_f32 v[46:47], v[46:47], v[142:143] op_sel_hi:[1,0]
    v_add_f32 v143, v52, v53
    v_cvt_pk_bf16_f32 v68, v36, v37
    v_cvt_pk_bf16_f32 v69, v38, v39
    v_cvt_pk_bf16_f32 v70, v40, v41
    v_cvt_pk_bf16_f32 v71, v42, v43
    v_cvt_pk_bf16_f32 v72, v44, v45
    v_cvt_pk_bf16_f32 v73, v46, v47
    v_min_u32 v68, -2, v68
    v_min_u32 v69, -2, v69
    v_min_u32 v70, -2, v70
    v_min_u32 v71, -2, v71
    v_min_u32 v72, -2, v72
    v_min_u32 v73, -2, v73
    v_mov_b32 v1, 163784
    s_cmp_eq_u32 s63, 1
    s_cbranch_scc1 PB_LAST
    v_add_f32 v143, v143, v48
    s_mov_b32 s52, 0x35800000
    s_mov_b32 s53, 0x53800000
    v_cmp_nge_f32 s[94:95], v143, s52
    v_cmp_nle_f32 vcc, v143, s53
    s_nop 0
    s_or_b64 s[94:95], s[94:95], vcc
    s_cbranch_scc1 PB_BAD
    buffer_store_dwordx4 v[68:71], v232, s[36:39], s48 offen sc1
    s_mov_b32 exec_hi, 0
    buffer_store_dwordx2 v[72:73], v233, s[36:39], s49 offen sc1
    s_mov_b64 exec, -1
    s_mov_b32 s50, 1
PB_CHECKED:
    s_waitcnt lgkmcnt(0)
    s_barrier
    ds_read_b32 v2, v1
    s_waitcnt lgkmcnt(0)
    v_readfirstlane_b32 s52, v2
    s_nop 0
    s_cmp_eq_u32 s52, 0
    s_cbranch_scc0 PB_SLOW
    s_branch PB_DONE
PB_BAD:
    ds_write_b32 v1, v138
    s_branch PB_CHECKED
PB_LAST:
    s_cmp_eq_u32 s50, 1
    s_cbranch_scc1 PB_LAST2
    buffer_store_dwordx4 v[68:71], v232, s[36:39], s48 offen sc1
    s_mov_b32 exec_hi, 0
    buffer_store_dwordx2 v[72:73], v233, s[36:39], s49 offen sc1
    s_mov_b64 exec, -1
PB_LAST2:
    s_barrier
    s_branch PB_DONE
PB_SPIN0:
    s_mov_b32 s89, 20000000
PB_SPINL0:
    ds_read_b32 v139, v137
    s_waitcnt lgkmcnt(0)
    s_sub_u32 s89, s89, 1
    s_cbranch_scc1 PB_SPUN0
    v_readfirstlane_b32 s52, v139
    s_nop 0
    s_cmp_ge_u32 s52, s61
    s_cbranch_scc0 PB_SPINL0
    s_branch PB_SPUN0
PB_SPIN1:
    s_mov_b32 s89, 20000000
PB_SPINL1:
    ds_read_b32 v139, v137
    s_waitcnt lgkmcnt(0)
    s_sub_u32 s89, s89, 1
    s_cbranch_scc1 PB_SPUN1
    v_readfirstlane_b32 s52, v139
    s_nop 0
    s_cmp_ge_u32 s52, s61
    s_cbranch_scc0 PB_SPINL1
    s_branch PB_SPUN1
PB_NODMA1:
    s_waitcnt vmcnt(0)
    s_mov_b32 s40, s8
    s_mov_b32 s41, s9
    s_mov_b32 s42, 819200
    s_mov_b32 s43, 0x00020000
    s_mul_i32 s57, s82, 15360
    s_lshl_b32 s52, s83, 10
    s_add_u32 s52, s52, s57
    s_mul_i32 s44, s82, 409600
    s_add_u32 s45, s44, 204800
    s_add_u32 s46, s44, 358400
    buffer_load_dword v245, v248, s[40:43], s46 offen
    buffer_load_dword v245, v249, s[40:43], s44 offen
    buffer_load_dword v245, v249, s[40:43], s45 offen
    s_mul_i32 s52, s83, 5120
    s_add_u32 s52, s52, s57
    s_cmp_eq_u32 s83, 0
    s_cbranch_scc0 PC_WP1
    buffer_load_dword v245, v246, s[40:43], s46 offen
    s_branch PC_WP3
PC_WP1:
    s_cmp_eq_u32 s83, 3
    s_cbranch_scc1 PC_WP3
    s_cmp_eq_u32 s83, 1
    s_cselect_b32 s44, s44, s45
    buffer_load_dword v245, v247, s[40:43], s44 offen
PC_WP3:
    s_branch PB_DMAD1
PB_SPIN2:
    s_mov_b32 s89, 20000000
PB_SPINL2:
    ds_read_b32 v139, v137
    s_waitcnt lgkmcnt(0)
    s_sub_u32 s89, s89, 1
    s_cbranch_scc1 PB_SPUN2
    v_readfirstlane_b32 s52, v139
    s_nop 0
    s_cmp_ge_u32 s52, s61
    s_cbranch_scc0 PB_SPINL2
    s_branch PB_SPUN2
PB_NODMA2:
    s_waitcnt vmcnt(0)
    s_add_u32 s44, s28, 10485760
    s_addc_u32 s45, s29, 0
    s_mov_b32 s46, 2621440
    s_mov_b32 s47, 0x00020000
    s_add_u32 m0, s88, 0
    s_nop 0
    buffer_load_dwordx4 v250, s[44:47], 0 offen sc1 lds
    s_add_u32 m0, s88, 1024
    s_nop 0
    buffer_load_dwordx4 v251, s[44:47], 0 offen sc1 lds
    s_add_u32 m0, s88, 1536
    s_nop 0
    buffer_load_dwordx4 v252, s[44:47], 0 offen sc1 lds
    s_add_u32 s44, s28, 15728640
    s_addc_u32 s45, s29, 0
    s_mov_b32 s46, 8192
    s_mov_b32 s47, 0x00020000
    buffer_load_dword v244, v254, s[44:47], 0 offen sc1
    s_mov_b32 s44, s4
    s_mov_b32 s45, s5
    s_mov_b32 s46, 2621440
    s_mov_b32 s47, 0x00020000
    buffer_load_dwordx2 v[238:239], v253, s[44:47], 0 offen offset:0
    buffer_load_dwordx2 v[240:241], v253, s[44:47], 0 offen offset:32
    buffer_load_dwordx2 v[242:243], v253, s[44:47], 0 offen offset:64
    s_branch PB_DMAD2
PB_SPIN3:
    s_mov_b32 s89, 20000000
PB_SPINL3:
    ds_read_b32 v139, v137
    s_waitcnt lgkmcnt(0)
    s_sub_u32 s89, s89, 1
    s_cbranch_scc1 PB_SPUN3
    v_readfirstlane_b32 s52, v139
    s_nop 0
    s_cmp_ge_u32 s52, s61
    s_cbranch_scc0 PB_SPINL3
    s_branch PB_SPUN3
PB_NODMA3:
    s_waitcnt vmcnt(0)
    s_branch PB_DMAD3
PB_SLOW:
    s_waitcnt vmcnt(0)
    s_mul_i32 s52, s83, 2576
    s_add_u32 s52, s52, 30912
    v_add_u32 v176, s52, v124
    v_add_u32 v177, s52, v125
    v_add_u32 v178, s52, v126
    v_add_u32 v179, s52, v127
    v_add_u32 v180, s52, v128
    v_add_u32 v181, s52, v129
    s_add_u32 m0, s62, 30912
    v_mov_b32 v76, 0xff800000
    v_mov_b32 v77, 0xff800000
    s_mov_b32 s60, 0
PB_SLOW1:
    buffer_load_dwordx4 v136, s[32:35], s60 offen sc1 lds
    buffer_load_dwordx4 v136, s[32:35], s60 offen offset:1024 sc1 lds
    buffer_load_dwordx4 v136, s[32:35], s60 offen offset:1536 sc1 lds
    s_add_u32 s60, s60, 2560
    s_waitcnt vmcnt(0)
    ds_read_b64 v[96:97], v176 offset:0
    ds_read_b64 v[98:99], v176 offset:256
    ds_read_b64 v[100:101], v177 offset:1024
    s_waitcnt lgkmcnt(0)
    v_mfma_f32_32x32x16_bf16 v[36:51], v[96:99], v[84:87], 0
    v_mfma_f32_32x32x8_bf16 v[36:51], v[100:101], v[88:89], v[36:51]
    v_mfma_f32_32x32x16_bf16 v[52:67], v[96:99], v[90:93], 0
    v_mfma_f32_32x32x8_bf16 v[52:67], v[100:101], v[94:95], v[52:67]
    s_nop 9
    v_max3_f32 v76, v36, v37, v76
    v_max3_f32 v76, v38, v39, v76
    v_max3_f32 v76, v40, v41, v76
    v_max3_f32 v76, v42, v43, v76
    v_max3_f32 v76, v44, v45, v76
    v_max3_f32 v76, v46, v47, v76
    v_max3_f32 v76, v48, v49, v76
    v_max3_f32 v76, v50, v51, v76
    v_max3_f32 v77, v52, v53, v77
    v_max3_f32 v77, v54, v55, v77
    v_max3_f32 v77, v56, v57, v77
    v_max3_f32 v77, v58, v59, v77
    v_max3_f32 v77, v60, v61, v77
    v_max3_f32 v77, v62, v63, v77
    v_max3_f32 v77, v64, v65, v77
    v_max3_f32 v77, v66, v67, v77
    s_cmp_lt_u32 s60, 81920
    s_cbranch_scc1 PB_SLOW1
    s_lshl_b32 s52, s3, 9
    s_add_u32 s52, s52, 154112
    v_lshlrev_b32 v1, 2, v255
    v_add_u32 v2, s52, v1
    ds_write_b32 v2, v76
    ds_write_b32 v2, v77 offset:256
    s_waitcnt lgkmcnt(0)
    s_barrier
    s_lshl_b32 s52, s83, 9
    s_add_u32 s52, s52, 154112
    v_and_b32 v1, 127, v1
    v_add_u32 v2, s52, v1
    ds_read_b32 v36, v2 offset:0
    ds_read_b32 v37, v2 offset:128
    ds_read_b32 v38, v2 offset:2048
    ds_read_b32 v39, v2 offset:2176
    ds_read_b32 v40, v2 offset:256
    ds_read_b32 v41, v2 offset:384
    ds_read_b32 v42, v2 offset:2304
    ds_read_b32 v43, v2 offset:2432
    s_waitcnt lgkmcnt(0)
    v_max3_f32 v76, v36, v37, v38
    v_max_f32 v76, v76, v39
    v_max3_f32 v77, v40, v41, v42
    v_max_f32 v77, v77, v43
    v_sub_f32 v144, 0xc1300000, v76
    v_sub_f32 v145, 0xc1300000, v76
    v_sub_f32 v146, 0xc1300000, v76
    v_sub_f32 v147, 0xc1300000, v76
    v_sub_f32 v148, 0xc1300000, v76
    v_sub_f32 v149, 0xc1300000, v76
    v_sub_f32 v150, 0xc1300000, v76
    v_sub_f32 v151, 0xc1300000, v76
    v_sub_f32 v152, 0xc1300000, v76
    v_sub_f32 v153, 0xc1300000, v76
    v_sub_f32 v154, 0xc1300000, v76
    v_sub_f32 v155, 0xc1300000, v76
    v_sub_f32 v156, 0xc1300000, v76
    v_sub_f32 v157, 0xc1300000, v76
    v_sub_f32 v158, 0xc1300000, v76
    v_sub_f32 v159, 0xc1300000, v76
    v_sub_f32 v160, 0xc1300000, v77
    v_sub_f32 v161, 0xc1300000, v77
    v_sub_f32 v162, 0xc1300000, v77
    v_sub_f32 v163, 0xc1300000, v77
    v_sub_f32 v164, 0xc1300000, v77
    v_sub_f32 v165, 0xc1300000, v77
    v_sub_f32 v166, 0xc1300000, v77
    v_sub_f32 v167, 0xc1300000, v77
    v_sub_f32 v168, 0xc1300000, v77
    v_sub_f32 v169, 0xc1300000, v77
    v_sub_f32 v170, 0xc1300000, v77
    v_sub_f32 v171, 0xc1300000, v77
    v_sub_f32 v172, 0xc1300000, v77
    v_sub_f32 v173, 0xc1300000, v77
    v_sub_f32 v174, 0xc1300000, v77
    v_sub_f32 v175, 0xc1300000, v77
    v_mov_b32 v4, 0
    v_mov_b32 v5, 0
    v_mov_b32 v6, 0
    v_mov_b32 v7, 0
    v_mov_b32 v8, 0
    v_mov_b32 v9, 0
    v_mov_b32 v10, 0
    v_mov_b32 v11, 0
    v_mov_b32 v12, 0
    v_mov_b32 v13, 0
    v_mov_b32 v14, 0
    v_mov_b32 v15, 0
    v_mov_b32 v16, 0
    v_mov_b32 v17, 0
    v_mov_b32 v18, 0
    v_mov_b32 v19, 0
    v_mov_b32 v20, 0
    v_mov_b32 v21, 0
    v_mov_b32 v22, 0
    v_mov_b32 v23, 0
    v_mov_b32 v24, 0
    v_mov_b32 v25, 0
    v_mov_b32 v26, 0
    v_mov_b32 v27, 0
    v_mov_b32 v28, 0
    v_mov_b32 v29, 0
    v_mov_b32 v30, 0
    v_mov_b32 v31, 0
    v_mov_b32 v32, 0
    v_mov_b32 v33, 0
    v_mov_b32 v34, 0
    v_mov_b32 v35, 0
    s_mov_b32 s60, 0
PB_SLOW2:
    buffer_load_dwordx4 v136, s[32:35], s60 offen sc1 lds
    buffer_load_dwordx4 v136, s[32:35], s60 offen offset:1024 sc1 lds
    buffer_load_dwordx4 v136, s[32:35], s60 offen offset:1536 sc1 lds
    s_add_u32 s60, s60, 2560
    s_waitcnt vmcnt(0)
    ds_read_b64 v[96:97], v176 offset:0
    ds_read_b64 v[98:99], v176 offset:256
    ds_read_b64 v[100:101], v177 offset:1024
    ds_read_b64_tr_b16 v[108:109], v178 offset:0
    ds_read_b64_tr_b16 v[110:111], v179 offset:0
    ds_read_b64_tr_b16 v[112:113], v180 offset:0
    ds_read_b64_tr_b16 v[114:115], v181 offset:0
    s_waitcnt lgkmcnt(0)
    v_mfma_f32_32x32x16_bf16 v[36:51], v[96:99], v[84:87], v[144:159]
    v_mfma_f32_32x32x8_bf16 v[36:51], v[100:101], v[88:89], v[36:51]
    s_nop 11
    v_exp_f32 v36, v36
    v_exp_f32 v37, v37
    v_exp_f32 v38, v38
    v_exp_f32 v39, v39
    v_exp_f32 v40, v40
    v_exp_f32 v41, v41
    v_exp_f32 v42, v42
    v_exp_f32 v43, v43
    v_exp_f32 v44, v44
    v_exp_f32 v45, v45
    v_exp_f32 v46, v46
    v_exp_f32 v47, v47
    v_exp_f32 v48, v48
    v_exp_f32 v49, v49
    v_exp_f32 v50, v50
    v_exp_f32 v51, v51
    v_cvt_pk_bf16_f32 v68, v36, v37
    v_cvt_pk_bf16_f32 v69, v38, v39
    v_cvt_pk_bf16_f32 v70, v40, v41
    v_cvt_pk_bf16_f32 v71, v42, v43
    v_cvt_pk_bf16_f32 v72, v44, v45
    v_cvt_pk_bf16_f32 v73, v46, v47
    v_cvt_pk_bf16_f32 v74, v48, v49
    v_cvt_pk_bf16_f32 v75, v50, v51
    v_mfma_f32_32x32x16_bf16 v[4:19], v[108:111], v[68:71], v[4:19]
    s_nop 0
    v_mfma_f32_32x32x16_bf16 v[4:19], v[112:115], v[72:75], v[4:19]
    v_mfma_f32_32x32x16_bf16 v[52:67], v[96:99], v[90:93], v[160:175]
    v_mfma_f32_32x32x8_bf16 v[52:67], v[100:101], v[94:95], v[52:67]
    s_nop 11
    v_exp_f32 v52, v52
    v_exp_f32 v53, v53
    v_exp_f32 v54, v54
    v_exp_f32 v55, v55
    v_exp_f32 v56, v56
    v_exp_f32 v57, v57
    v_exp_f32 v58, v58
    v_exp_f32 v59, v59
    v_exp_f32 v60, v60
    v_exp_f32 v61, v61
    v_exp_f32 v62, v62
    v_exp_f32 v63, v63
    v_exp_f32 v64, v64
    v_exp_f32 v65, v65
    v_exp_f32 v66, v66
    v_exp_f32 v67, v67
    v_cvt_pk_bf16_f32 v68, v52, v53
    v_cvt_pk_bf16_f32 v69, v54, v55
    v_cvt_pk_bf16_f32 v70, v56, v57
    v_cvt_pk_bf16_f32 v71, v58, v59
    v_cvt_pk_bf16_f32 v72, v60, v61
    v_cvt_pk_bf16_f32 v73, v62, v63
    v_cvt_pk_bf16_f32 v74, v64, v65
    v_cvt_pk_bf16_f32 v75, v66, v67
    v_mfma_f32_32x32x16_bf16 v[20:35], v[108:111], v[68:71], v[20:35]
    s_nop 0
    v_mfma_f32_32x32x16_bf16 v[20:35], v[112:115], v[72:75], v[20:35]
    s_cmp_lt_u32 s60, 81920
    s_cbranch_scc1 PB_SLOW2
    s_mov_b32 s63, 1
    s_branch PB_COMBINE
F_OOL1:
    s_cmp_ge_u32 s85, 4
    s_cbranch_scc1 F_OOL1A
    v_mov_b32 v1, 163776
    s_mov_b32 s89, 20000000
LW_31:
    ds_read_b32 v2, v1
    s_sub_u32 s89, s89, 1
    s_cbranch_scc1 LE_32
    s_waitcnt lgkmcnt(0)
    v_readfirstlane_b32 s52, v2
    s_nop 0
    s_cmp_ge_u32 s52, 4
    s_cbranch_scc0 LW_31
LE_32:
F_OOL1A:
    s_cmp_eq_u32 s83, 0
    s_cbranch_scc0 F_OOL1B
    s_lshl_b32 s52, s30, 5
    s_add_u32 s52, s52, s31
    s_lshl_b32 s52, s52, 5
    s_add_u32 s52, s52, 16384
    s_add_u32 s44, s28, 15794176
    s_addc_u32 s45, s29, 0
    s_mov_b32 s46, 24576
    s_mov_b32 s47, 0x00020000
    v_mov_b32 v1, 0
    v_mov_b32 v2, 1
    s_mov_b64 exec, 1
    buffer_store_dword v2, v1, s[44:47], s52 offen sc1
    s_mov_b64 exec, -1
F_OOL1B:
    s_mov_b32 s40, s8
    s_mov_b32 s41, s9
    s_mov_b32 s42, 819200
    s_mov_b32 s43, 0x00020000
    s_lshl_b32 s52, s83, 10
    s_add_u32 m0, s52, 82432
    s_mov_b32 s53, 0
    buffer_load_dwordx4 v248, s[40:43], s53 offen  lds
    s_add_u32 m0, s52, 97792
    s_mov_b32 s53, 153600
    buffer_load_dwordx4 v248, s[40:43], s53 offen  lds
    s_add_u32 m0, s52, 113152
    s_mov_b32 s53, 307200
    buffer_load_dwordx4 v248, s[40:43], s53 offen  lds
    s_add_u32 m0, s52, 128512
    s_mov_b32 s53, 512000
    buffer_load_dwordx4 v248, s[40:43], s53 offen  lds
    s_add_u32 m0, s52, 143872
    s_mov_b32 s53, 665600
    buffer_load_dwordx4 v248, s[40:43], s53 offen  lds
    s_add_u32 s52, s83, 0
    s_cmp_ge_u32 s52, 7
    s_addc_u32 s53, s52, 0
    s_mul_i32 s53, s53, 51200
    s_mul_i32 s52, s52, 5120
    s_add_u32 m0, s52, 86528
    s_nop 0
    buffer_load_dwordx4 v246, s[40:43], s53 offen  lds
    s_add_u32 s52, s83, 12
    s_cmp_ge_u32 s52, 14
    s_cbranch_scc1 PC_WOSKIP
    s_cmp_ge_u32 s52, 7
    s_addc_u32 s53, s52, 0
    s_mul_i32 s53, s53, 51200
    s_mul_i32 s52, s52, 5120
    s_add_u32 m0, s52, 86528
    s_nop 0
    buffer_load_dwordx4 v246, s[40:43], s53 offen  lds
PC_WOSKIP:
    s_branch F_OOR1
F_OOL2:
    s_mov_b32 s40, s8
    s_mov_b32 s41, s9
    s_mov_b32 s42, 819200
    s_mov_b32 s43, 0x00020000
    s_lshl_b32 s52, s83, 10
    s_add_u32 m0, s52, 87552
    s_mov_b32 s53, 51200
    buffer_load_dwordx4 v248, s[40:43], s53 offen  lds
    s_add_u32 m0, s52, 102912
    s_mov_b32 s53, 204800
    buffer_load_dwordx4 v248, s[40:43], s53 offen  lds
    s_add_u32 m0, s52, 118272
    s_mov_b32 s53, 409600
    buffer_load_dwordx4 v248, s[40:43], s53 offen  lds
    s_add_u32 m0, s52, 133632
    s_mov_b32 s53, 563200
    buffer_load_dwordx4 v248, s[40:43], s53 offen  lds
    s_add_u32 m0, s52, 148992
    s_mov_b32 s53, 716800
    buffer_load_dwordx4 v248, s[40:43], s53 offen  lds
    s_add_u32 s52, s83, 4
    s_cmp_ge_u32 s52, 7
    s_addc_u32 s53, s52, 0
    s_mul_i32 s53, s53, 51200
    s_mul_i32 s52, s52, 5120
    s_add_u32 m0, s52, 86528
    s_nop 0
    buffer_load_dwordx4 v246, s[40:43], s53 offen  lds
    s_branch F_OOR2
F_OOL3:
    s_cmp_eq_u32 s83, 0
    s_cbranch_scc0 F_OOL3B
    s_add_u32 s44, s28, 15794176
    s_addc_u32 s45, s29, 0
    s_mov_b32 s46, 24576
    s_mov_b32 s47, 0x00020000
    buffer_load_dword v245, v237, s[44:47], 0 offen sc1
    buffer_load_dword v235, v236, s[44:47], 0 offen sc1
    s_cmp_eq_u32 s82, 0
    s_cbranch_scc1 F_OOR3
F_OOL3B:
    s_mov_b32 s40, s8
    s_mov_b32 s41, s9
    s_mov_b32 s42, 819200
    s_mov_b32 s43, 0x00020000
    s_lshl_b32 s52, s83, 10
    s_add_u32 m0, s52, 92672
    s_mov_b32 s53, 102400
    buffer_load_dwordx4 v248, s[40:43], s53 offen  lds
    s_add_u32 m0, s52, 108032
    s_mov_b32 s53, 256000
    buffer_load_dwordx4 v248, s[40:43], s53 offen  lds
    s_add_u32 m0, s52, 123392
    s_mov_b32 s53, 460800
    buffer_load_dwordx4 v248, s[40:43], s53 offen  lds
    s_add_u32 m0, s52, 138752
    s_mov_b32 s53, 614400
    buffer_load_dwordx4 v248, s[40:43], s53 offen  lds
    s_add_u32 s52, s83, 8
    s_cmp_ge_u32 s52, 7
    s_addc_u32 s53, s52, 0
    s_mul_i32 s53, s53, 51200
    s_mul_i32 s52, s52, 5120
    s_add_u32 m0, s52, 86528
    s_nop 0
    buffer_load_dwordx4 v246, s[40:43], s53 offen  lds
    s_branch F_OOR3
F_OOL0:
    v_and_b32 v245, v245, v235
    v_cmp_ne_u32 s[94:95], 1, v245
    s_nop 0
    s_cmp_eq_u64 s[94:95], 0
    s_cbranch_scc1 F_OOR0
    s_add_u32 s44, s28, 15794176
    s_addc_u32 s45, s29, 0
    s_mov_b32 s46, 24576
    s_mov_b32 s47, 0x00020000
    s_mov_b32 s89, 400000
SP_33:
    buffer_load_dword v245, v237, s[44:47], 0 offen sc1
    buffer_load_dword v235, v236, s[44:47], 0 offen sc1
    s_waitcnt vmcnt(0)
    v_and_b32 v245, v245, v235
    v_cmp_ne_u32 s[94:95], 1, v245
    s_nop 0
    s_cmp_eq_u64 s[94:95], 0
    s_cbranch_scc1 SE_34
    s_sub_u32 s89, s89, 1
    s_cbranch_scc0 SP_33
SE_34:
    s_branch F_OOR0
PB_DONE:
    s_mov_b32 s40, s8
    s_mov_b32 s41, s9
    s_mov_b32 s42, 819200
    s_mov_b32 s43, 0x00020000
    s_mul_i32 s57, s82, 15360
    s_lshl_b32 s52, s83, 10
    s_add_u32 s52, s52, s57
    s_mul_i32 s44, s82, 409600
    s_add_u32 s45, s44, 204800
    s_add_u32 s46, s44, 358400
    s_add_u32 m0, s52, 10304
    s_nop 0
    buffer_load_dwordx4 v248, s[40:43], s46 offen lds
    s_add_u32 m0, s52, 15424
    s_nop 0
    buffer_load_dwordx4 v249, s[40:43], s44 offen lds
    s_add_u32 m0, s52, 20544
    s_nop 0
    buffer_load_dwordx4 v249, s[40:43], s45 offen lds
    s_mul_i32 s52, s83, 5120
    s_add_u32 s52, s52, s57
    s_add_u32 m0, s52, 14400
    s_cmp_eq_u32 s83, 0
    s_cbranch_scc0 PC_WL1
    buffer_load_dwordx4 v246, s[40:43], s46 offen lds
    s_branch PC_WL3
PC_WL1:
    s_cmp_eq_u32 s83, 3
    s_cbranch_scc1 PC_WL3
    s_cmp_eq_u32 s83, 1
    s_cselect_b32 s44, s44, s45
    buffer_load_dwordx4 v247, s[40:43], s44 offen lds
PC_WL3:
    s_lshl_b32 s52, s86, 2
    s_add_u32 s52, s52, s83
    s_mul_i32 s52, s52, 20480
    s_add_u32 s52, s52, 13107200
    s_add_u32 s32, s28, s52
    s_addc_u32 s33, s29, 0
    s_mov_b32 s34, 20480
    s_mov_b32 s35, 0x00020000
    s_mov_b32 s40, s24
    s_mov_b32 s41, s25
    s_mov_b32 s42, 2621440
    s_mov_b32 s43, 0x00020000
    s_mul_i32 s52, s86, 81920
    s_mul_i32 s53, s87, 160
    s_add_u32 s55, s52, s53
    ds_read_b64_tr_b16 v[104:105], v212 offset:0
    ds_read_b64_tr_b16 v[106:107], v212 offset:512
    ds_read_b64_tr_b16 v[108:109], v212 offset:1024
    v_sub_f32 v1, 1.0, v244
    s_waitcnt lgkmcnt(0)
    v_lshlrev_b32 v2, 16, v238
    v_and_b32 v3, 0xffff0000, v238
    v_lshlrev_b32 v120, 16, v104
    v_and_b32 v121, 0xffff0000, v104
    v_mul_f32 v2, v2, v1
    v_mul_f32 v3, v3, v1
    v_mul_f32 v120, v120, v2
    v_mul_f32 v121, v121, v3
    v_lshlrev_b32 v2, 16, v239
    v_and_b32 v3, 0xffff0000, v239
    v_lshlrev_b32 v122, 16, v105
    v_and_b32 v123, 0xffff0000, v105
    v_mul_f32 v2, v2, v1
    v_mul_f32 v3, v3, v1
    v_mul_f32 v122, v122, v2
    v_mul_f32 v123, v123, v3
    v_lshlrev_b32 v2, 16, v240
    v_and_b32 v3, 0xffff0000, v240
    v_lshlrev_b32 v124, 16, v106
    v_and_b32 v125, 0xffff0000, v106
    v_mul_f32 v2, v2, v1
    v_mul_f32 v3, v3, v1
    v_mul_f32 v124, v124, v2
    v_mul_f32 v125, v125, v3
    v_lshlrev_b32 v2, 16, v241
    v_and_b32 v3, 0xffff0000, v241
    v_lshlrev_b32 v126, 16, v107
    v_and_b32 v127, 0xffff0000, v107
    v_mul_f32 v2, v2, v1
    v_mul_f32 v3, v3, v1
    v_mul_f32 v126, v126, v2
    v_mul_f32 v127, v127, v3
    v_lshlrev_b32 v2, 16, v242
    v_and_b32 v3, 0xffff0000, v242
    v_lshlrev_b32 v128, 16, v108
    v_and_b32 v129, 0xffff0000, v108
    v_mul_f32 v2, v2, v1
    v_mul_f32 v3, v3, v1
    v_mul_f32 v128, v128, v2
    v_mul_f32 v129, v129, v3
    v_lshlrev_b32 v2, 16, v243
    v_and_b32 v3, 0xffff0000, v243
    v_lshlrev_b32 v130, 16, v109
    v_and_b32 v131, 0xffff0000, v109
    v_mul_f32 v2, v2, v1
    v_mul_f32 v3, v3, v1
    v_mul_f32 v130, v130, v2
    v_mul_f32 v131, v131, v3
    v_mov_b32 v4, 0
    v_mov_b32 v5, 0
    v_mov_b32 v6, 0
    v_mov_b32 v7, 0
    v_mov_b32 v8, 0
    v_mov_b32 v9, 0
    v_mov_b32 v10, 0
    v_mov_b32 v11, 0
    v_mov_b32 v12, 0
    v_mov_b32 v13, 0
    v_mov_b32 v14, 0
    v_mov_b32 v15, 0
    v_mov_b32 v16, 0
    v_mov_b32 v17, 0
    v_mov_b32 v18, 0
    v_mov_b32 v19, 0
    v_mov_b32 v20, 0
    v_mov_b32 v21, 0
    v_mov_b32 v22, 0
    v_mov_b32 v23, 0
    s_waitcnt vmcnt(0)
    s_barrier
    buffer_load_dwordx4 v[24:27], v216, s[32:35], 0 offen offset:0 sc1
    buffer_load_dwordx4 v[28:31], v216, s[32:35], 0 offen offset:1024 sc1
    buffer_load_dwordx2 v[56:57], v217, s[32:35], 0 offen offset:0 sc1
    s_mov_b32 s51, 15
    s_mov_b32 s89, 400000
    s_mov_b32 s54, 1
PC_ROUND:
    s_bitcmp1_b32 s51, 0
    s_cbranch_scc0 PC_T0
    ds_read_b64_tr_b16 v[64:65], v210 offset:0
    ds_read_b64_tr_b16 v[66:67], v210 offset:2560
    ds_read_b64_tr_b16 v[68:69], v210 offset:32
    ds_read_b64_tr_b16 v[70:71], v210 offset:2592
    ds_read_b64_tr_b16 v[72:73], v210 offset:64
    ds_read_b64_tr_b16 v[74:75], v210 offset:2624
    ds_read_b64_tr_b16 v[76:77], v210 offset:96
    ds_read_b64_tr_b16 v[78:79], v210 offset:2656
    ds_read_b64_tr_b16 v[80:81], v210 offset:128
    ds_read_b64_tr_b16 v[82:83], v210 offset:2688
    s_waitcnt vmcnt(0)
    s_cmp_eq_u32 s54, 0
    s_cbranch_scc1 PC_N0
    buffer_load_dwordx4 v[32:35], v216, s[32:35], 0 offen offset:2048 sc1
    buffer_load_dwordx4 v[36:39], v216, s[32:35], 0 offen offset:3072 sc1
    buffer_load_dwordx2 v[58:59], v217, s[32:35], 0 offen offset:512 sc1
PC_N0:
    v_max3_u32 v1, v24, v25, v26
    v_max3_u32 v2, v27, v28, v29
    v_max3_u32 v1, v30, v31, v1
    v_max3_u32 v2, v56, v57, v2
    v_max_u32 v1, v1, v2
    v_cmp_eq_u32 s[94:95], -1, v1
    s_nop 0
    s_cmp_eq_u64 s[94:95], 0
    s_cbranch_scc1 PC_OK0
    buffer_load_dwordx4 v[24:27], v216, s[32:35], 0 offen offset:0 sc1
    buffer_load_dwordx4 v[28:31], v216, s[32:35], 0 offen offset:1024 sc1
    buffer_load_dwordx2 v[56:57], v217, s[32:35], 0 offen offset:0 sc1
    s_branch PC_T0
PC_OK0:
    s_bitset0_b32 s51, 0
    s_waitcnt lgkmcnt(0)
    v_mfma_f32_16x16x32_bf16 v[4:7], v[64:67], v[24:27], v[4:7]
    ds_read_b64_tr_b16 v[84:85], v210 offset:5120
    ds_read_b64_tr_b16 v[86:87], v210 offset:7680
    v_mfma_f32_16x16x32_bf16 v[8:11], v[68:71], v[24:27], v[8:11]
    ds_read_b64_tr_b16 v[88:89], v210 offset:5152
    ds_read_b64_tr_b16 v[90:91], v210 offset:7712
    v_mfma_f32_16x16x32_bf16 v[12:15], v[72:75], v[24:27], v[12:15]
    ds_read_b64_tr_b16 v[92:93], v210 offset:5184
    ds_read_b64_tr_b16 v[94:95], v210 offset:7744
    v_mfma_f32_16x16x32_bf16 v[16:19], v[76:79], v[24:27], v[16:19]
    ds_read_b64_tr_b16 v[96:97], v210 offset:5216
    ds_read_b64_tr_b16 v[98:99], v210 offset:7776
    v_mfma_f32_16x16x32_bf16 v[20:23], v[80:83], v[24:27], v[20:23]
    ds_read_b64_tr_b16 v[100:101], v210 offset:5248
    ds_read_b64_tr_b16 v[102:103], v210 offset:7808
    s_bitcmp1_b32 s51, 1
    s_cbranch_scc0 PC_P0
    s_waitcnt lgkmcnt(0)
    v_mfma_f32_16x16x32_bf16 v[4:7], v[84:87], v[28:31], v[4:7]
    v_mfma_f32_16x16x32_bf16 v[8:11], v[88:91], v[28:31], v[8:11]
    v_mfma_f32_16x16x32_bf16 v[12:15], v[92:95], v[28:31], v[12:15]
    v_mfma_f32_16x16x32_bf16 v[16:19], v[96:99], v[28:31], v[16:19]
    v_mfma_f32_16x16x32_bf16 v[20:23], v[100:103], v[28:31], v[20:23]
    s_branch PC_T0
PC_P0:
    s_waitcnt lgkmcnt(0)
    v_mfma_f32_16x16x32_bf16 v[4:7], v[84:87], v[28:31], v[4:7]
    ds_read_b64_tr_b16 v[64:65], v211 offset:5120
    ds_read_b64_tr_b16 v[66:67], v211 offset:7680
    v_mfma_f32_16x16x32_bf16 v[8:11], v[88:91], v[28:31], v[8:11]
    ds_read_b64_tr_b16 v[68:69], v211 offset:5152
    ds_read_b64_tr_b16 v[70:71], v211 offset:7712
    v_mfma_f32_16x16x32_bf16 v[12:15], v[92:95], v[28:31], v[12:15]
    ds_read_b64_tr_b16 v[72:73], v211 offset:5184
    ds_read_b64_tr_b16 v[74:75], v211 offset:7744
    v_mfma_f32_16x16x32_bf16 v[16:19], v[96:99], v[28:31], v[16:19]
    ds_read_b64_tr_b16 v[76:77], v211 offset:5216
    ds_read_b64_tr_b16 v[78:79], v211 offset:7776
    v_mfma_f32_16x16x32_bf16 v[20:23], v[100:103], v[28:31], v[20:23]
    ds_read_b64_tr_b16 v[80:81], v211 offset:5248
    ds_read_b64_tr_b16 v[82:83], v211 offset:7808
    s_waitcnt lgkmcnt(0)
    v_mfma_f32_16x16x32_bf16 v[4:7], v[64:67], v[56:59], v[4:7]
    v_mfma_f32_16x16x32_bf16 v[8:11], v[68:71], v[56:59], v[8:11]
    v_mfma_f32_16x16x32_bf16 v[12:15], v[72:75], v[56:59], v[12:15]
    v_mfma_f32_16x16x32_bf16 v[16:19], v[76:79], v[56:59], v[16:19]
    v_mfma_f32_16x16x32_bf16 v[20:23], v[80:83], v[56:59], v[20:23]
PC_T0:
    s_bitcmp1_b32 s51, 1
    s_cbranch_scc0 PC_T1
    ds_read_b64_tr_b16 v[64:65], v210 offset:10240
    ds_read_b64_tr_b16 v[66:67], v210 offset:12800
    ds_read_b64_tr_b16 v[68:69], v210 offset:10272
    ds_read_b64_tr_b16 v[70:71], v210 offset:12832
    ds_read_b64_tr_b16 v[72:73], v210 offset:10304
    ds_read_b64_tr_b16 v[74:75], v210 offset:12864
    ds_read_b64_tr_b16 v[76:77], v210 offset:10336
    ds_read_b64_tr_b16 v[78:79], v210 offset:12896
    ds_read_b64_tr_b16 v[80:81], v210 offset:10368
    ds_read_b64_tr_b16 v[82:83], v210 offset:12928
    s_waitcnt vmcnt(0)
    s_cmp_eq_u32 s54, 0
    s_cbranch_scc1 PC_N1
    buffer_load_dwordx4 v[40:43], v218, s[32:35], 0 offen offset:0 sc1
    buffer_load_dwordx4 v[44:47], v218, s[32:35], 0 offen offset:1024 sc1
    buffer_load_dwordx2 v[60:61], v217, s[32:35], 0 offen offset:1024 sc1
PC_N1:
    v_max3_u32 v1, v32, v33, v34
    v_max3_u32 v2, v35, v36, v37
    v_max3_u32 v1, v38, v39, v1
    v_max3_u32 v2, v58, v59, v2
    v_max_u32 v1, v1, v2
    v_cmp_eq_u32 s[94:95], -1, v1
    s_nop 0
    s_cmp_eq_u64 s[94:95], 0
    s_cbranch_scc1 PC_OK1
    buffer_load_dwordx4 v[32:35], v216, s[32:35], 0 offen offset:2048 sc1
    buffer_load_dwordx4 v[36:39], v216, s[32:35], 0 offen offset:3072 sc1
    buffer_load_dwordx2 v[58:59], v217, s[32:35], 0 offen offset:512 sc1
    s_branch PC_T1
PC_OK1:
    s_bitset0_b32 s51, 1
    s_waitcnt lgkmcnt(0)
    v_mfma_f32_16x16x32_bf16 v[4:7], v[64:67], v[32:35], v[4:7]
    ds_read_b64_tr_b16 v[84:85], v210 offset:15360
    ds_read_b64_tr_b16 v[86:87], v210 offset:17920
    v_mfma_f32_16x16x32_bf16 v[8:11], v[68:71], v[32:35], v[8:11]
    ds_read_b64_tr_b16 v[88:89], v210 offset:15392
    ds_read_b64_tr_b16 v[90:91], v210 offset:17952
    v_mfma_f32_16x16x32_bf16 v[12:15], v[72:75], v[32:35], v[12:15]
    ds_read_b64_tr_b16 v[92:93], v210 offset:15424
    ds_read_b64_tr_b16 v[94:95], v210 offset:17984
    v_mfma_f32_16x16x32_bf16 v[16:19], v[76:79], v[32:35], v[16:19]
    ds_read_b64_tr_b16 v[96:97], v210 offset:15456
    ds_read_b64_tr_b16 v[98:99], v210 offset:18016
    v_mfma_f32_16x16x32_bf16 v[20:23], v[80:83], v[32:35], v[20:23]
    ds_read_b64_tr_b16 v[100:101], v210 offset:15488
    ds_read_b64_tr_b16 v[102:103], v210 offset:18048
    s_bitcmp1_b32 s51, 0
    s_cbranch_scc0 PC_P1
    s_waitcnt lgkmcnt(0)
    v_mfma_f32_16x16x32_bf16 v[4:7], v[84:87], v[36:39], v[4:7]
    v_mfma_f32_16x16x32_bf16 v[8:11], v[88:91], v[36:39], v[8:11]
    v_mfma_f32_16x16x32_bf16 v[12:15], v[92:95], v[36:39], v[12:15]
    v_mfma_f32_16x16x32_bf16 v[16:19], v[96:99], v[36:39], v[16:19]
    v_mfma_f32_16x16x32_bf16 v[20:23], v[100:103], v[36:39], v[20:23]
    s_branch PC_T1
PC_P1:
    s_waitcnt lgkmcnt(0)
    v_mfma_f32_16x16x32_bf16 v[4:7], v[84:87], v[36:39], v[4:7]
    ds_read_b64_tr_b16 v[64:65], v211 offset:5120
    ds_read_b64_tr_b16 v[66:67], v211 offset:7680
    v_mfma_f32_16x16x32_bf16 v[8:11], v[88:91], v[36:39], v[8:11]
    ds_read_b64_tr_b16 v[68:69], v211 offset:5152
    ds_read_b64_tr_b16 v[70:71], v211 offset:7712
    v_mfma_f32_16x16x32_bf16 v[12:15], v[92:95], v[36:39], v[12:15]
    ds_read_b64_tr_b16 v[72:73], v211 offset:5184
    ds_read_b64_tr_b16 v[74:75], v211 offset:7744
    v_mfma_f32_16x16x32_bf16 v[16:19], v[96:99], v[36:39], v[16:19]
    ds_read_b64_tr_b16 v[76:77], v211 offset:5216
    ds_read_b64_tr_b16 v[78:79], v211 offset:7776
    v_mfma_f32_16x16x32_bf16 v[20:23], v[100:103], v[36:39], v[20:23]
    ds_read_b64_tr_b16 v[80:81], v211 offset:5248
    ds_read_b64_tr_b16 v[82:83], v211 offset:7808
    s_waitcnt lgkmcnt(0)
    v_mfma_f32_16x16x32_bf16 v[4:7], v[64:67], v[56:59], v[4:7]
    v_mfma_f32_16x16x32_bf16 v[8:11], v[68:71], v[56:59], v[8:11]
    v_mfma_f32_16x16x32_bf16 v[12:15], v[72:75], v[56:59], v[12:15]
    v_mfma_f32_16x16x32_bf16 v[16:19], v[76:79], v[56:59], v[16:19]
    v_mfma_f32_16x16x32_bf16 v[20:23], v[80:83], v[56:59], v[20:23]
PC_T1:
    s_bitcmp1_b32 s51, 2
    s_cbranch_scc0 PC_T2
    ds_read_b64_tr_b16 v[64:65], v210 offset:20480
    ds_read_b64_tr_b16 v[66:67], v210 offset:23040
    ds_read_b64_tr_b16 v[68:69], v210 offset:20512
    ds_read_b64_tr_b16 v[70:71], v210 offset:23072
    ds_read_b64_tr_b16 v[72:73], v210 offset:20544
    ds_read_b64_tr_b16 v[74:75], v210 offset:23104
    ds_read_b64_tr_b16 v[76:77], v210 offset:20576
    ds_read_b64_tr_b16 v[78:79], v210 offset:23136
    ds_read_b64_tr_b16 v[80:81], v210 offset:20608
    ds_read_b64_tr_b16 v[82:83], v210 offset:23168
    s_waitcnt vmcnt(0)
    s_cmp_eq_u32 s54, 0
    s_cbranch_scc1 PC_N2
    buffer_load_dwordx4 v[48:51], v218, s[32:35], 0 offen offset:2048 sc1
    buffer_load_dwordx4 v[52:55], v218, s[32:35], 0 offen offset:3072 sc1
    buffer_load_dwordx2 v[62:63], v217, s[32:35], 0 offen offset:1536 sc1
PC_N2:
    v_max3_u32 v1, v40, v41, v42
    v_max3_u32 v2, v43, v44, v45
    v_max3_u32 v1, v46, v47, v1
    v_max3_u32 v2, v60, v61, v2
    v_max_u32 v1, v1, v2
    v_cmp_eq_u32 s[94:95], -1, v1
    s_nop 0
    s_cmp_eq_u64 s[94:95], 0
    s_cbranch_scc1 PC_OK2
    buffer_load_dwordx4 v[40:43], v218, s[32:35], 0 offen offset:0 sc1
    buffer_load_dwordx4 v[44:47], v218, s[32:35], 0 offen offset:1024 sc1
    buffer_load_dwordx2 v[60:61], v217, s[32:35], 0 offen offset:1024 sc1
    s_branch PC_T2
PC_OK2:
    s_bitset0_b32 s51, 2
    s_waitcnt lgkmcnt(0)
    v_mfma_f32_16x16x32_bf16 v[4:7], v[64:67], v[40:43], v[4:7]
    ds_read_b64_tr_b16 v[84:85], v210 offset:25600
    ds_read_b64_tr_b16 v[86:87], v210 offset:28160
    v_mfma_f32_16x16x32_bf16 v[8:11], v[68:71], v[40:43], v[8:11]
    ds_read_b64_tr_b16 v[88:89], v210 offset:25632
    ds_read_b64_tr_b16 v[90:91], v210 offset:28192
    v_mfma_f32_16x16x32_bf16 v[12:15], v[72:75], v[40:43], v[12:15]
    ds_read_b64_tr_b16 v[92:93], v210 offset:25664
    ds_read_b64_tr_b16 v[94:95], v210 offset:28224
    v_mfma_f32_16x16x32_bf16 v[16:19], v[76:79], v[40:43], v[16:19]
    ds_read_b64_tr_b16 v[96:97], v210 offset:25696
    ds_read_b64_tr_b16 v[98:99], v210 offset:28256
    v_mfma_f32_16x16x32_bf16 v[20:23], v[80:83], v[40:43], v[20:23]
    ds_read_b64_tr_b16 v[100:101], v210 offset:25728
    ds_read_b64_tr_b16 v[102:103], v210 offset:28288
    s_bitcmp1_b32 s51, 3
    s_cbranch_scc0 PC_P2
    s_waitcnt lgkmcnt(0)
    v_mfma_f32_16x16x32_bf16 v[4:7], v[84:87], v[44:47], v[4:7]
    v_mfma_f32_16x16x32_bf16 v[8:11], v[88:91], v[44:47], v[8:11]
    v_mfma_f32_16x16x32_bf16 v[12:15], v[92:95], v[44:47], v[12:15]
    v_mfma_f32_16x16x32_bf16 v[16:19], v[96:99], v[44:47], v[16:19]
    v_mfma_f32_16x16x32_bf16 v[20:23], v[100:103], v[44:47], v[20:23]
    s_branch PC_T2
PC_P2:
    s_waitcnt lgkmcnt(0)
    v_mfma_f32_16x16x32_bf16 v[4:7], v[84:87], v[44:47], v[4:7]
    ds_read_b64_tr_b16 v[64:65], v211 offset:10240
    ds_read_b64_tr_b16 v[66:67], v211 offset:12800
    v_mfma_f32_16x16x32_bf16 v[8:11], v[88:91], v[44:47], v[8:11]
    ds_read_b64_tr_b16 v[68:69], v211 offset:10272
    ds_read_b64_tr_b16 v[70:71], v211 offset:12832
    v_mfma_f32_16x16x32_bf16 v[12:15], v[92:95], v[44:47], v[12:15]
    ds_read_b64_tr_b16 v[72:73], v211 offset:10304
    ds_read_b64_tr_b16 v[74:75], v211 offset:12864
    v_mfma_f32_16x16x32_bf16 v[16:19], v[96:99], v[44:47], v[16:19]
    ds_read_b64_tr_b16 v[76:77], v211 offset:10336
    ds_read_b64_tr_b16 v[78:79], v211 offset:12896
    v_mfma_f32_16x16x32_bf16 v[20:23], v[100:103], v[44:47], v[20:23]
    ds_read_b64_tr_b16 v[80:81], v211 offset:10368
    ds_read_b64_tr_b16 v[82:83], v211 offset:12928
    s_waitcnt lgkmcnt(0)
    v_mfma_f32_16x16x32_bf16 v[4:7], v[64:67], v[60:63], v[4:7]
    v_mfma_f32_16x16x32_bf16 v[8:11], v[68:71], v[60:63], v[8:11]
    v_mfma_f32_16x16x32_bf16 v[12:15], v[72:75], v[60:63], v[12:15]
    v_mfma_f32_16x16x32_bf16 v[16:19], v[76:79], v[60:63], v[16:19]
    v_mfma_f32_16x16x32_bf16 v[20:23], v[80:83], v[60:63], v[20:23]
PC_T2:
    s_bitcmp1_b32 s51, 3
    s_cbranch_scc0 PC_T3
    ds_read_b64_tr_b16 v[64:65], v210 offset:30720
    ds_read_b64_tr_b16 v[66:67], v210 offset:33280
    ds_read_b64_tr_b16 v[68:69], v210 offset:30752
    ds_read_b64_tr_b16 v[70:71], v210 offset:33312
    ds_read_b64_tr_b16 v[72:73], v210 offset:30784
    ds_read_b64_tr_b16 v[74:75], v210 offset:33344
    ds_read_b64_tr_b16 v[76:77], v210 offset:30816
    ds_read_b64_tr_b16 v[78:79], v210 offset:33376
    ds_read_b64_tr_b16 v[80:81], v210 offset:30848
    ds_read_b64_tr_b16 v[82:83], v210 offset:33408
    s_waitcnt vmcnt(0)
    v_max3_u32 v1, v48, v49, v50
    v_max3_u32 v2, v51, v52, v53
    v_max3_u32 v1, v54, v55, v1
    v_max3_u32 v2, v62, v63, v2
    v_max_u32 v1, v1, v2
    v_cmp_eq_u32 s[94:95], -1, v1
    s_nop 0
    s_cmp_eq_u64 s[94:95], 0
    s_cbranch_scc1 PC_OK3
    buffer_load_dwordx4 v[48:51], v218, s[32:35], 0 offen offset:2048 sc1
    buffer_load_dwordx4 v[52:55], v218, s[32:35], 0 offen offset:3072 sc1
    buffer_load_dwordx2 v[62:63], v217, s[32:35], 0 offen offset:1536 sc1
    s_branch PC_T3
PC_OK3:
    s_bitset0_b32 s51, 3
    s_waitcnt lgkmcnt(0)
    v_mfma_f32_16x16x32_bf16 v[4:7], v[64:67], v[48:51], v[4:7]
    ds_read_b64_tr_b16 v[84:85], v211 offset:0
    ds_read_b64_tr_b16 v[86:87], v211 offset:2560
    v_mfma_f32_16x16x32_bf16 v[8:11], v[68:71], v[48:51], v[8:11]
    ds_read_b64_tr_b16 v[88:89], v211 offset:32
    ds_read_b64_tr_b16 v[90:91], v211 offset:2592
    v_mfma_f32_16x16x32_bf16 v[12:15], v[72:75], v[48:51], v[12:15]
    ds_read_b64_tr_b16 v[92:93], v211 offset:64
    ds_read_b64_tr_b16 v[94:95], v211 offset:2624
    v_mfma_f32_16x16x32_bf16 v[16:19], v[76:79], v[48:51], v[16:19]
    ds_read_b64_tr_b16 v[96:97], v211 offset:96
    ds_read_b64_tr_b16 v[98:99], v211 offset:2656
    v_mfma_f32_16x16x32_bf16 v[20:23], v[80:83], v[48:51], v[20:23]
    ds_read_b64_tr_b16 v[100:101], v211 offset:128
    ds_read_b64_tr_b16 v[102:103], v211 offset:2688
    s_bitcmp1_b32 s51, 2
    s_cbranch_scc0 PC_P3
    s_waitcnt lgkmcnt(0)
    v_mfma_f32_16x16x32_bf16 v[4:7], v[84:87], v[52:55], v[4:7]
    v_mfma_f32_16x16x32_bf16 v[8:11], v[88:91], v[52:55], v[8:11]
    v_mfma_f32_16x16x32_bf16 v[12:15], v[92:95], v[52:55], v[12:15]
    v_mfma_f32_16x16x32_bf16 v[16:19], v[96:99], v[52:55], v[16:19]
    v_mfma_f32_16x16x32_bf16 v[20:23], v[100:103], v[52:55], v[20:23]
    s_branch PC_T3
PC_P3:
    s_waitcnt lgkmcnt(0)
    v_mfma_f32_16x16x32_bf16 v[4:7], v[84:87], v[52:55], v[4:7]
    ds_read_b64_tr_b16 v[64:65], v211 offset:10240
    ds_read_b64_tr_b16 v[66:67], v211 offset:12800
    v_mfma_f32_16x16x32_bf16 v[8:11], v[88:91], v[52:55], v[8:11]
    ds_read_b64_tr_b16 v[68:69], v211 offset:10272
    ds_read_b64_tr_b16 v[70:71], v211 offset:12832
    v_mfma_f32_16x16x32_bf16 v[12:15], v[92:95], v[52:55], v[12:15]
    ds_read_b64_tr_b16 v[72:73], v211 offset:10304
    ds_read_b64_tr_b16 v[74:75], v211 offset:12864
    v_mfma_f32_16x16x32_bf16 v[16:19], v[96:99], v[52:55], v[16:19]
    ds_read_b64_tr_b16 v[76:77], v211 offset:10336
    ds_read_b64_tr_b16 v[78:79], v211 offset:12896
    v_mfma_f32_16x16x32_bf16 v[20:23], v[100:103], v[52:55], v[20:23]
    ds_read_b64_tr_b16 v[80:81], v211 offset:10368
    ds_read_b64_tr_b16 v[82:83], v211 offset:12928
    s_waitcnt lgkmcnt(0)
    v_mfma_f32_16x16x32_bf16 v[4:7], v[64:67], v[60:63], v[4:7]
    v_mfma_f32_16x16x32_bf16 v[8:11], v[68:71], v[60:63], v[8:11]
    v_mfma_f32_16x16x32_bf16 v[12:15], v[72:75], v[60:63], v[12:15]
    v_mfma_f32_16x16x32_bf16 v[16:19], v[76:79], v[60:63], v[16:19]
    v_mfma_f32_16x16x32_bf16 v[20:23], v[80:83], v[60:63], v[20:23]
PC_T3:
    s_cmp_eq_u32 s51, 0
    s_cbranch_scc1 PC_ALL
    s_mov_b32 s54, 0
    s_waitcnt vmcnt(0) lgkmcnt(0)
    s_sub_u32 s89, s89, 1
    s_cbranch_scc0 PC_ROUND
PC_ALL:
    s_cmp_eq_u32 s82, 0
    s_cbranch_scc0 PC_K1
    v_fma_f32 v4, v4, v244, v120
    v_fma_f32 v5, v5, v244, v121
    v_fma_f32 v6, v6, v244, v122
    v_fma_f32 v7, v7, v244, v123
    ds_write_b128 v215, v[4:7] offset:0
    v_fma_f32 v8, v8, v244, v124
    v_fma_f32 v9, v9, v244, v125
    v_fma_f32 v10, v10, v244, v126
    v_fma_f32 v11, v11, v244, v127
    ds_write_b128 v215, v[8:11] offset:64
    v_fma_f32 v12, v12, v244, v128
    v_fma_f32 v13, v13, v244, v129
    v_fma_f32 v14, v14, v244, v130
    v_fma_f32 v15, v15, v244, v131
    ds_write_b128 v215, v[12:15] offset:128
    v_mul_f32 v16, v16, v244
    v_mul_f32 v17, v17, v244
    v_mul_f32 v18, v18, v244
    v_mul_f32 v19, v19, v244
    ds_write_b128 v215, v[16:19] offset:192
    v_mul_f32 v20, v20, v244
    v_mul_f32 v21, v21, v244
    v_mul_f32 v22, v22, v244
    v_mul_f32 v23, v23, v244
    ds_write_b128 v215, v[20:23] offset:256
    s_branch PC_ST
PC_K1:
    v_mul_f32 v4, v4, v244
    v_mul_f32 v5, v5, v244
    v_mul_f32 v6, v6, v244
    v_mul_f32 v7, v7, v244
    ds_write_b128 v215, v[4:7] offset:0
    v_mul_f32 v8, v8, v244
    v_mul_f32 v9, v9, v244
    v_mul_f32 v10, v10, v244
    v_mul_f32 v11, v11, v244
    ds_write_b128 v215, v[8:11] offset:64
    v_mul_f32 v12, v12, v244
    v_mul_f32 v13, v13, v244
    v_mul_f32 v14, v14, v244
    v_mul_f32 v15, v15, v244
    ds_write_b128 v215, v[12:15] offset:128
    v_fma_f32 v16, v16, v244, v124
    v_fma_f32 v17, v17, v244, v125
    v_fma_f32 v18, v18, v244, v126
    v_fma_f32 v19, v19, v244, v127
    ds_write_b128 v215, v[16:19] offset:192
    v_fma_f32 v20, v20, v244, v128
    v_fma_f32 v21, v21, v244, v129
    v_fma_f32 v22, v22, v244, v130
    v_fma_f32 v23, v23, v244, v131
    ds_write_b128 v215, v[20:23] offset:256
PC_ST:
    s_waitcnt lgkmcnt(0)
    s_barrier
    ds_read_b128 v[24:27], v221 offset:0
    ds_read_b128 v[28:31], v221 offset:16
    ds_read_b128 v[32:35], v222 offset:0
    ds_read_b128 v[36:39], v222 offset:16
    s_cmp_lt_u32 s3, 2
    s_cbranch_scc0 PC_ONE
    ds_read_b128 v[40:43], v224 offset:0
    ds_read_b128 v[44:47], v224 offset:16
    ds_read_b128 v[48:51], v225 offset:0
    ds_read_b128 v[52:55], v225 offset:16
    s_waitcnt lgkmcnt(5)
    v_add_f32 v24, v24, v32
    v_add_f32 v25, v25, v33
    v_add_f32 v26, v26, v34
    v_add_f32 v27, v27, v35
    s_waitcnt lgkmcnt(4)
    v_add_f32 v28, v28, v36
    v_add_f32 v29, v29, v37
    v_add_f32 v30, v30, v38
    v_add_f32 v31, v31, v39
    v_cvt_pk_bf16_f32 v32, v24, v25
    v_cvt_pk_bf16_f32 v33, v26, v27
    v_cvt_pk_bf16_f32 v34, v28, v29
    v_cvt_pk_bf16_f32 v35, v30, v31
    buffer_store_dwordx4 v[32:35], v220, s[40:43], s55 offen
    s_waitcnt lgkmcnt(1)
    v_add_f32 v40, v40, v48
    v_add_f32 v41, v41, v49
    v_add_f32 v42, v42, v50
    v_add_f32 v43, v43, v51
    s_waitcnt lgkmcnt(0)
    v_add_f32 v44, v44, v52
    v_add_f32 v45, v45, v53
    v_add_f32 v46, v46, v54
    v_add_f32 v47, v47, v55
    v_cvt_pk_bf16_f32 v48, v40, v41
    v_cvt_pk_bf16_f32 v49, v42, v43
    v_cvt_pk_bf16_f32 v50, v44, v45
    v_cvt_pk_bf16_f32 v51, v46, v47
    buffer_store_dwordx4 v[48:51], v223, s[40:43], s55 offen
    s_branch PC_END
PC_ONE:
    s_waitcnt lgkmcnt(1)
    v_add_f32 v24, v24, v32
    v_add_f32 v25, v25, v33
    v_add_f32 v26, v26, v34
    v_add_f32 v27, v27, v35
    s_waitcnt lgkmcnt(0)
    v_add_f32 v28, v28, v36
    v_add_f32 v29, v29, v37
    v_add_f32 v30, v30, v38
    v_add_f32 v31, v31, v39
    v_cvt_pk_bf16_f32 v32, v24, v25
    v_cvt_pk_bf16_f32 v33, v26, v27
    v_cvt_pk_bf16_f32 v34, v28, v29
    v_cvt_pk_bf16_f32 v35, v30, v31
    buffer_store_dwordx4 v[32:35], v220, s[40:43], s55 offen
PC_END:
F_EXIT:
    s_endpgm
F_LAST:
.section .rodata,"a"
.p2align 6
.amdhsa_kernel gated_mix__mha_block__ssm_conv_h3__prompt_kernel
  .amdhsa_next_free_vgpr 256
  .amdhsa_next_free_sgpr 102
  .amdhsa_accum_offset 256
  .amdhsa_group_segment_fixed_size 0
  .amdhsa_kernarg_size 104
  .amdhsa_user_sgpr_count 2
  .amdhsa_user_sgpr_kernarg_segment_ptr 1
  .amdhsa_system_sgpr_workgroup_id_x 1
.end_amdhsa_kernel
```
